```python
import torch

def _softmax(x, axis=-1):
    return torch.softmax(x, dim=axis)
def _gelu(x):
    return torch.nn.functional.gelu(x, approximate="tanh")
def _silu(x):
    return torch.nn.functional.silu(x)
def _sigmoid(x):
    return torch.sigmoid(x)
def _layernorm(x, axis=-1, eps=1e-5):
    m = x.mean(dim=axis, keepdim=True)
    v = x.var(dim=axis, keepdim=True, unbiased=False)
    return (x - m) / torch.sqrt(v + eps)
def _scatter_add(tgt, idx, src, axis=0):
    return tgt.clone().index_add_(axis, idx, src)
def _segment_sum(src, seg, n):
    out = torch.zeros((n,) + src.shape[1:], dtype=src.dtype)
    return out.index_add_(0, seg, src)
def _pad(x, pw):
    flat = tuple(v for pair in reversed(pw) for v in pair)
    return torch.nn.functional.pad(x, flat)

kernel_name = 'recurrent_scan__ssm_conv_s5__mixer_token_mlp__prompt'

def setup_inputs():

    _w = (lambda a: (lambda t: t.to(torch.bfloat16) if t.is_floating_point() else t)(torch.as_tensor(a)))
    def _A_setup():
        B, S, D = 1, 2048, 512
        P = D
        Lambda_re = -0.5 * (lambda _x: torch.exp(torch.as_tensor(_x)))((lambda *s: torch.randn(*s, dtype=torch.bfloat16) * 0.4)(P))
        Lambda_im = (lambda *s: torch.randn(*s, dtype=torch.bfloat16) * 0.4)(P) * 1.0
        B_re = (lambda *s: torch.randn(*s, dtype=torch.bfloat16) * 0.4)(P, D) * (D ** -0.5)
        B_im = (lambda *s: torch.randn(*s, dtype=torch.bfloat16) * 0.4)(P, D) * (D ** -0.5)
        C_re = (lambda *s: torch.randn(*s, dtype=torch.bfloat16) * 0.4)(D, P) * (P ** -0.5)
        C_im = (lambda *s: torch.randn(*s, dtype=torch.bfloat16) * 0.4)(D, P) * (P ** -0.5)
        log_dt = (lambda *s: torch.randn(*s, dtype=torch.bfloat16) * 0.4)(P) * 0.3 - 2.0
        Dskip = (lambda *s: torch.randn(*s, dtype=torch.bfloat16) * 0.2)(D)
        return {
            "x": _w((lambda *s: torch.randn(*s, dtype=torch.bfloat16) * 0.05)(B, S, D)),
            "Lambda_re": _w(Lambda_re),
            "Lambda_im": _w(Lambda_im),
            "B_re": _w(B_re),
            "B_im": _w(B_im),
            "C_re": _w(C_re),
            "C_im": _w(C_im),
            "log_dt": _w(log_dt),
            "Dskip": _w(Dskip),
        }
    _A_in = _A_setup()

    def _B_setup():
        B, S, D, F = 1, 2048, 512, 1792
        return {
            "x": _w((lambda *s: torch.randn(*s, dtype=torch.bfloat16) * 0.05)(B, S, D)),
            "w1": _w((lambda *s: torch.randn(*s, dtype=torch.bfloat16) * 0.4)(S, F) * (S ** -0.5)),
            "b1": _w((lambda *s: torch.randn(*s, dtype=torch.bfloat16) * 3.2)(F) * 0.02),
            "w2": _w((lambda *s: torch.randn(*s, dtype=torch.bfloat16) * 0.4)(F, S) * (F ** -0.5)),
            "b2": _w((lambda *s: torch.randn(*s, dtype=torch.bfloat16) * 0.8)(S) * 0.02),
        }
    _B_in = _B_setup()

    return {
        "A_x": _A_in["x"],
        "A_Lambda_re": _A_in["Lambda_re"],
        "A_Lambda_im": _A_in["Lambda_im"],
        "A_B_re": _A_in["B_re"],
        "A_B_im": _A_in["B_im"],
        "A_C_re": _A_in["C_re"],
        "A_C_im": _A_in["C_im"],
        "A_log_dt": _A_in["log_dt"],
        "A_Dskip": _A_in["Dskip"],
        "B_x": _B_in["x"],
        "B_w1": _B_in["w1"],
        "B_b1": _B_in["b1"],
        "B_w2": _B_in["w2"],
        "B_b2": _B_in["b2"],
    }

def reference(A_x, A_Lambda_re, A_Lambda_im, A_B_re, A_B_im, A_C_re, A_C_im, A_log_dt, A_Dskip, B_x, B_w1, B_b1, B_w2, B_b2):
    def _A_ref(x, Lambda_re, Lambda_im, B_re, B_im, C_re, C_im, log_dt, Dskip):
        Bsz, L, H = x.shape
        Lam = Lambda_re + 1j * Lambda_im
        Bmat = B_re + 1j * B_im
        Cmat = C_re + 1j * C_im
        dt = torch.exp(log_dt)
        Lam_bar = torch.exp(dt * Lam)
        B_bar = ((Lam_bar - 1.0) / Lam)[:, None] * Bmat
        Bu = torch.einsum("bld,pd->blp", x + 0j, B_bar)
        h = torch.zeros_like(Bu[:, 0, :])
        hs = []
        for t in range(L):
            h = Lam_bar[None, :] * h + Bu[:, t, :]
            hs.append(h)
        hseq = torch.stack(hs, 1)
        y = 2.0 * torch.einsum("blp,dp->bld", hseq, Cmat).real + x * Dskip[None, None, :]
        return y

    def _B_ref(x, w1, b1, w2, b2):
        B, S, D = x.shape
        h = _layernorm(x, axis=-1)
        u = torch.einsum("bsd,sf->bdf", h, w1) + b1
        u = _gelu(u)
        y = torch.einsum("bdf,fs->bds", u, w2) + b2
        return (lambda x, *d: x.permute(*d))(y, 0, 2, 1)

    x = A_x
    xn = _layernorm(x, axis=-1)
    s = _A_ref(xn, A_Lambda_re, A_Lambda_im, A_B_re, A_B_im, A_C_re, A_C_im, A_log_dt, A_Dskip)
    g = _silu(_B_ref(xn, B_w1, B_b1, B_w2, B_b2))
    return x + s * g
```

```asm
; @launch kernel=ln_kernel grid=(641,1,1) block=(256,1,1) lds=0
; @launch kernel=c1_kernel grid=(384,1,1) block=(256,1,1) lds=73728
; @launch kernel=mid_kernel grid=(352,1,1) block=(256,1,1) lds=65536
; @launch kernel=fin_kernel grid=(256,1,1) block=(256,1,1) lds=65536
.amdgcn_target "amdgcn-amd-amdhsa--gfx950"
.text
.globl ln_kernel
.p2align 8
.type ln_kernel,@function
ln_kernel:
  s_load_dwordx2 s[4:5], s[0:1], 0
  s_load_dwordx2 s[6:7], s[0:1], 128
  s_cmp_ge_u32 s2, 641
  s_cbranch_scc1 ln_end
  s_cmp_ge_u32 s2, 513
  s_cbranch_scc1 ln_pref
  s_cmp_eq_u32 s2, 512
  s_cbranch_scc1 ln_params
  v_lshrrev_b32 v1, 6, v0
  s_nop 1
  v_readfirstlane_b32 s3, v1
  s_lshl_b32 s16, s2, 2
  s_nop 2
  s_add_u32 s16, s16, s3
  s_lshl_b32 s16, s16, 10
  v_and_b32 v1, 63, v0
  v_lshlrev_b32 v1, 4, v1
  s_waitcnt lgkmcnt(0)
  s_mov_b32 s8, s4
  s_mov_b32 s9, s5
  s_mov_b32 s10, 0x200000
  s_mov_b32 s11, 0x00020000
  s_mov_b32 s12, s6
  s_mov_b32 s13, s7
  s_mov_b32 s14, 0x10000000
  s_mov_b32 s15, 0x00020000
  buffer_load_dwordx4 v[4:7], v1, s[8:11], s16 offen
  s_waitcnt vmcnt(0)
  v_lshlrev_b32 v8, 16, v4
  v_and_b32 v9, 0xffff0000, v4
  v_lshlrev_b32 v10, 16, v5
  v_and_b32 v11, 0xffff0000, v5
  v_lshlrev_b32 v12, 16, v6
  v_and_b32 v13, 0xffff0000, v6
  v_lshlrev_b32 v14, 16, v7
  v_and_b32 v15, 0xffff0000, v7
  v_add_f32 v16, v8, v9
  v_add_f32 v16, v16, v10
  v_add_f32 v16, v16, v11
  v_add_f32 v16, v16, v12
  v_add_f32 v16, v16, v13
  v_add_f32 v16, v16, v14
  v_add_f32 v16, v16, v15
  s_nop 1
  v_add_f32_dpp v16, v16, v16 row_shr:1 row_mask:0xf bank_mask:0xf bound_ctrl:0
  s_nop 1
  v_add_f32_dpp v16, v16, v16 row_shr:2 row_mask:0xf bank_mask:0xf bound_ctrl:0
  s_nop 1
  v_add_f32_dpp v16, v16, v16 row_shr:4 row_mask:0xf bank_mask:0xf bound_ctrl:0
  s_nop 1
  v_add_f32_dpp v16, v16, v16 row_shr:8 row_mask:0xf bank_mask:0xf bound_ctrl:0
  s_nop 1
  v_add_f32_dpp v16, v16, v16 row_bcast:15 row_mask:0xa bank_mask:0xf
  s_nop 1
  v_add_f32_dpp v16, v16, v16 row_bcast:31 row_mask:0xc bank_mask:0xf
  s_nop 1
  v_readlane_b32 s20, v16, 63
  s_nop 3
  v_mov_b32 v17, s20
  v_mul_f32 v17, 0x3b000000, v17
  v_sub_f32 v18, v8, v17
  v_sub_f32 v19, v9, v17
  v_sub_f32 v20, v10, v17
  v_sub_f32 v21, v11, v17
  v_sub_f32 v22, v12, v17
  v_sub_f32 v23, v13, v17
  v_sub_f32 v24, v14, v17
  v_sub_f32 v25, v15, v17
  v_mul_f32 v16, v18, v18
  v_fmac_f32 v16, v19, v19
  v_fmac_f32 v16, v20, v20
  v_fmac_f32 v16, v21, v21
  v_fmac_f32 v16, v22, v22
  v_fmac_f32 v16, v23, v23
  v_fmac_f32 v16, v24, v24
  v_fmac_f32 v16, v25, v25
  s_nop 1
  v_add_f32_dpp v16, v16, v16 row_shr:1 row_mask:0xf bank_mask:0xf bound_ctrl:0
  s_nop 1
  v_add_f32_dpp v16, v16, v16 row_shr:2 row_mask:0xf bank_mask:0xf bound_ctrl:0
  s_nop 1
  v_add_f32_dpp v16, v16, v16 row_shr:4 row_mask:0xf bank_mask:0xf bound_ctrl:0
  s_nop 1
  v_add_f32_dpp v16, v16, v16 row_shr:8 row_mask:0xf bank_mask:0xf bound_ctrl:0
  s_nop 1
  v_add_f32_dpp v16, v16, v16 row_bcast:15 row_mask:0xa bank_mask:0xf
  s_nop 1
  v_add_f32_dpp v16, v16, v16 row_bcast:31 row_mask:0xc bank_mask:0xf
  s_nop 1
  v_readlane_b32 s21, v16, 63
  s_nop 3
  v_mov_b32 v16, s21
  v_mul_f32 v16, 0x3b000000, v16
  v_cvt_pk_bf16_f32 v26, v16, v16
  v_lshlrev_b32 v16, 16, v26
  v_add_f32 v16, 0x3727c5ac, v16
  v_cvt_pk_bf16_f32 v26, v16, v16
  v_lshlrev_b32 v16, 16, v26
  v_sqrt_f32 v16, v16
  s_nop 1
  v_cvt_pk_bf16_f32 v26, v16, v16
  v_lshlrev_b32 v16, 16, v26
  v_rcp_f32 v16, v16
  s_nop 1
  v_cvt_pk_bf16_f32 v26, v17, v17
  v_lshlrev_b32 v17, 16, v26
  v_sub_f32 v18, v8, v17
  v_sub_f32 v19, v9, v17
  v_sub_f32 v20, v10, v17
  v_sub_f32 v21, v11, v17
  v_sub_f32 v22, v12, v17
  v_sub_f32 v23, v13, v17
  v_sub_f32 v24, v14, v17
  v_sub_f32 v25, v15, v17
  v_cvt_pk_bf16_f32 v26, v18, v19
  v_lshlrev_b32 v18, 16, v26
  v_and_b32 v19, 0xffff0000, v26
  v_cvt_pk_bf16_f32 v26, v20, v21
  v_lshlrev_b32 v20, 16, v26
  v_and_b32 v21, 0xffff0000, v26
  v_cvt_pk_bf16_f32 v26, v22, v23
  v_lshlrev_b32 v22, 16, v26
  v_and_b32 v23, 0xffff0000, v26
  v_cvt_pk_bf16_f32 v26, v24, v25
  v_lshlrev_b32 v24, 16, v26
  v_and_b32 v25, 0xffff0000, v26
  v_mul_f32 v18, v18, v16
  v_mul_f32 v19, v19, v16
  v_mul_f32 v20, v20, v16
  v_mul_f32 v21, v21, v16
  v_mul_f32 v22, v22, v16
  v_mul_f32 v23, v23, v16
  v_mul_f32 v24, v24, v16
  v_mul_f32 v25, v25, v16
  v_cvt_pk_bf16_f32 v4, v18, v19
  v_lshlrev_b32 v8, 16, v4
  v_and_b32 v9, 0xffff0000, v4
  v_cvt_pk_bf16_f32 v5, v20, v21
  v_lshlrev_b32 v10, 16, v5
  v_and_b32 v11, 0xffff0000, v5
  v_cvt_pk_bf16_f32 v6, v22, v23
  v_lshlrev_b32 v12, 16, v6
  v_and_b32 v13, 0xffff0000, v6
  v_cvt_pk_bf16_f32 v7, v24, v25
  v_lshlrev_b32 v14, 16, v7
  v_and_b32 v15, 0xffff0000, v7
  s_add_u32 s17, s16, 0x0
  buffer_store_dwordx4 v[4:7], v1, s[12:15], s17 offen
  v_add_f32 v16, v8, v9
  v_add_f32 v16, v16, v10
  v_add_f32 v16, v16, v11
  v_add_f32 v16, v16, v12
  v_add_f32 v16, v16, v13
  v_add_f32 v16, v16, v14
  v_add_f32 v16, v16, v15
  s_nop 1
  v_add_f32_dpp v16, v16, v16 row_shr:1 row_mask:0xf bank_mask:0xf bound_ctrl:0
  s_nop 1
  v_add_f32_dpp v16, v16, v16 row_shr:2 row_mask:0xf bank_mask:0xf bound_ctrl:0
  s_nop 1
  v_add_f32_dpp v16, v16, v16 row_shr:4 row_mask:0xf bank_mask:0xf bound_ctrl:0
  s_nop 1
  v_add_f32_dpp v16, v16, v16 row_shr:8 row_mask:0xf bank_mask:0xf bound_ctrl:0
  s_nop 1
  v_add_f32_dpp v16, v16, v16 row_bcast:15 row_mask:0xa bank_mask:0xf
  s_nop 1
  v_add_f32_dpp v16, v16, v16 row_bcast:31 row_mask:0xc bank_mask:0xf
  s_nop 1
  v_readlane_b32 s20, v16, 63
  s_nop 3
  v_mov_b32 v17, s20
  v_mul_f32 v17, 0x3b000000, v17
  v_sub_f32 v18, v8, v17
  v_sub_f32 v19, v9, v17
  v_sub_f32 v20, v10, v17
  v_sub_f32 v21, v11, v17
  v_sub_f32 v22, v12, v17
  v_sub_f32 v23, v13, v17
  v_sub_f32 v24, v14, v17
  v_sub_f32 v25, v15, v17
  v_mul_f32 v16, v18, v18
  v_fmac_f32 v16, v19, v19
  v_fmac_f32 v16, v20, v20
  v_fmac_f32 v16, v21, v21
  v_fmac_f32 v16, v22, v22
  v_fmac_f32 v16, v23, v23
  v_fmac_f32 v16, v24, v24
  v_fmac_f32 v16, v25, v25
  s_nop 1
  v_add_f32_dpp v16, v16, v16 row_shr:1 row_mask:0xf bank_mask:0xf bound_ctrl:0
  s_nop 1
  v_add_f32_dpp v16, v16, v16 row_shr:2 row_mask:0xf bank_mask:0xf bound_ctrl:0
  s_nop 1
  v_add_f32_dpp v16, v16, v16 row_shr:4 row_mask:0xf bank_mask:0xf bound_ctrl:0
  s_nop 1
  v_add_f32_dpp v16, v16, v16 row_shr:8 row_mask:0xf bank_mask:0xf bound_ctrl:0
  s_nop 1
  v_add_f32_dpp v16, v16, v16 row_bcast:15 row_mask:0xa bank_mask:0xf
  s_nop 1
  v_add_f32_dpp v16, v16, v16 row_bcast:31 row_mask:0xc bank_mask:0xf
  s_nop 1
  v_readlane_b32 s21, v16, 63
  s_nop 3
  v_mov_b32 v16, s21
  v_mul_f32 v16, 0x3b000000, v16
  v_cvt_pk_bf16_f32 v26, v16, v16
  v_lshlrev_b32 v16, 16, v26
  v_add_f32 v16, 0x3727c5ac, v16
  v_cvt_pk_bf16_f32 v26, v16, v16
  v_lshlrev_b32 v16, 16, v26
  v_sqrt_f32 v16, v16
  s_nop 1
  v_cvt_pk_bf16_f32 v26, v16, v16
  v_lshlrev_b32 v16, 16, v26
  v_rcp_f32 v16, v16
  s_nop 1
  v_cvt_pk_bf16_f32 v26, v17, v17
  v_lshlrev_b32 v17, 16, v26
  v_sub_f32 v18, v8, v17
  v_sub_f32 v19, v9, v17
  v_sub_f32 v20, v10, v17
  v_sub_f32 v21, v11, v17
  v_sub_f32 v22, v12, v17
  v_sub_f32 v23, v13, v17
  v_sub_f32 v24, v14, v17
  v_sub_f32 v25, v15, v17
  v_cvt_pk_bf16_f32 v26, v18, v19
  v_lshlrev_b32 v18, 16, v26
  v_and_b32 v19, 0xffff0000, v26
  v_cvt_pk_bf16_f32 v26, v20, v21
  v_lshlrev_b32 v20, 16, v26
  v_and_b32 v21, 0xffff0000, v26
  v_cvt_pk_bf16_f32 v26, v22, v23
  v_lshlrev_b32 v22, 16, v26
  v_and_b32 v23, 0xffff0000, v26
  v_cvt_pk_bf16_f32 v26, v24, v25
  v_lshlrev_b32 v24, 16, v26
  v_and_b32 v25, 0xffff0000, v26
  v_mul_f32 v18, v18, v16
  v_mul_f32 v19, v19, v16
  v_mul_f32 v20, v20, v16
  v_mul_f32 v21, v21, v16
  v_mul_f32 v22, v22, v16
  v_mul_f32 v23, v23, v16
  v_mul_f32 v24, v24, v16
  v_mul_f32 v25, v25, v16
  v_cvt_pk_bf16_f32 v32, v18, v19
  v_lshlrev_b32 v8, 16, v32
  v_and_b32 v9, 0xffff0000, v32
  v_cvt_pk_bf16_f32 v33, v20, v21
  v_lshlrev_b32 v10, 16, v33
  v_and_b32 v11, 0xffff0000, v33
  v_cvt_pk_bf16_f32 v34, v22, v23
  v_lshlrev_b32 v12, 16, v34
  v_and_b32 v13, 0xffff0000, v34
  v_cvt_pk_bf16_f32 v35, v24, v25
  v_lshlrev_b32 v14, 16, v35
  v_and_b32 v15, 0xffff0000, v35
  s_add_u32 s17, s16, 0x200000
  buffer_store_dwordx4 v[32:35], v1, s[12:15], s17 offen
  s_branch ln_end
ln_params:
  s_load_dwordx2 s[16:17], s[0:1], 8
  s_load_dwordx2 s[18:19], s[0:1], 16
  s_load_dwordx2 s[20:21], s[0:1], 56
  s_waitcnt lgkmcnt(0)
  s_mov_b32 s8, s16
  s_mov_b32 s9, s17
  s_mov_b32 s10, 0x400
  s_mov_b32 s11, 0x00020000
  s_mov_b32 s24, s18
  s_mov_b32 s25, s19
  s_mov_b32 s26, 0x400
  s_mov_b32 s27, 0x00020000
  s_mov_b32 s28, s20
  s_mov_b32 s29, s21
  s_mov_b32 s30, 0x400
  s_mov_b32 s31, 0x00020000
  s_mov_b32 s12, s6
  s_mov_b32 s13, s7
  s_mov_b32 s14, 0x10000000
  s_mov_b32 s15, 0x00020000
  s_mov_b32 s22, 0x1400000
  v_add_u32 v1, 0, v0
  v_lshlrev_b32 v2, 1, v1
  buffer_load_ushort v4, v2, s[8:11], 0 offen
  buffer_load_ushort v5, v2, s[24:27], 0 offen
  buffer_load_ushort v6, v2, s[28:31], 0 offen
  s_waitcnt vmcnt(0)
  v_lshlrev_b32 v4, 16, v4
  v_lshlrev_b32 v5, 16, v5
  v_lshlrev_b32 v6, 16, v6
  v_mul_f32 v6, 0x3fb8aa3b, v6
  v_exp_f32 v6, v6
  s_nop 1
  v_cvt_pk_bf16_f32 v20, v6, v6
  v_lshlrev_b32 v6, 16, v20
  v_mul_f32 v7, v6, v4
  v_mul_f32 v8, v6, v5
  v_mul_f32 v7, 0x3fb8aa3b, v7
  v_exp_f32 v7, v7
  v_mul_f32 v8, 0x3e22f983, v8
  v_fract_f32 v8, v8
  v_sin_f32 v9, v8
  v_cos_f32 v10, v8
  s_nop 1
  v_mul_f32 v11, v7, v10
  v_mul_f32 v12, v7, v9
  v_add_f32 v13, -1.0, v11
  v_mul_f32 v14, v4, v4
  v_fmac_f32 v14, v5, v5
  v_rcp_f32 v14, v14
  v_mul_f32 v15, v13, v4
  v_fmac_f32 v15, v12, v5
  v_mul_f32 v16, v12, v4
  v_mul_f32 v17, v13, v5
  v_sub_f32 v16, v16, v17
  v_mul_f32 v15, v15, v14
  v_mul_f32 v16, v16, v14
  v_mov_b32 v17, v11
  v_mov_b32 v18, v12
  v_mul_f32 v19, v17, v17
  v_mul_f32 v20, v18, v18
  v_sub_f32 v19, v19, v20
  v_mul_f32 v18, v17, v18
  v_add_f32 v18, v18, v18
  v_mov_b32 v17, v19
  v_mul_f32 v19, v17, v17
  v_mul_f32 v20, v18, v18
  v_sub_f32 v19, v19, v20
  v_mul_f32 v18, v17, v18
  v_add_f32 v18, v18, v18
  v_mov_b32 v17, v19
  v_mul_f32 v19, v17, v17
  v_mul_f32 v20, v18, v18
  v_sub_f32 v19, v19, v20
  v_mul_f32 v18, v17, v18
  v_add_f32 v18, v18, v18
  v_mov_b32 v17, v19
  v_mul_f32 v19, v17, v17
  v_mul_f32 v20, v18, v18
  v_sub_f32 v19, v19, v20
  v_mul_f32 v18, v17, v18
  v_add_f32 v18, v18, v18
  v_mov_b32 v17, v19
  v_mul_f32 v19, v17, v17
  v_mul_f32 v20, v18, v18
  v_sub_f32 v19, v19, v20
  v_mul_f32 v18, v17, v18
  v_add_f32 v18, v18, v18
  v_mov_b32 v17, v19
  v_lshlrev_b32 v2, 2, v1
  v_add_u32 v3, 0, v2
  buffer_store_dword v11, v3, s[12:15], s22 offen
  v_add_u32 v3, 2048, v2
  buffer_store_dword v12, v3, s[12:15], s22 offen
  v_add_u32 v3, 4096, v2
  buffer_store_dword v15, v3, s[12:15], s22 offen
  v_add_u32 v3, 6144, v2
  buffer_store_dword v16, v3, s[12:15], s22 offen
  v_add_u32 v3, 8192, v2
  buffer_store_dword v17, v3, s[12:15], s22 offen
  v_add_u32 v3, 10240, v2
  buffer_store_dword v18, v3, s[12:15], s22 offen
  v_add_u32 v1, 256, v0
  v_lshlrev_b32 v2, 1, v1
  buffer_load_ushort v4, v2, s[8:11], 0 offen
  buffer_load_ushort v5, v2, s[24:27], 0 offen
  buffer_load_ushort v6, v2, s[28:31], 0 offen
  s_waitcnt vmcnt(0)
  v_lshlrev_b32 v4, 16, v4
  v_lshlrev_b32 v5, 16, v5
  v_lshlrev_b32 v6, 16, v6
  v_mul_f32 v6, 0x3fb8aa3b, v6
  v_exp_f32 v6, v6
  s_nop 1
  v_cvt_pk_bf16_f32 v20, v6, v6
  v_lshlrev_b32 v6, 16, v20
  v_mul_f32 v7, v6, v4
  v_mul_f32 v8, v6, v5
  v_mul_f32 v7, 0x3fb8aa3b, v7
  v_exp_f32 v7, v7
  v_mul_f32 v8, 0x3e22f983, v8
  v_fract_f32 v8, v8
  v_sin_f32 v9, v8
  v_cos_f32 v10, v8
  s_nop 1
  v_mul_f32 v11, v7, v10
  v_mul_f32 v12, v7, v9
  v_add_f32 v13, -1.0, v11
  v_mul_f32 v14, v4, v4
  v_fmac_f32 v14, v5, v5
  v_rcp_f32 v14, v14
  v_mul_f32 v15, v13, v4
  v_fmac_f32 v15, v12, v5
  v_mul_f32 v16, v12, v4
  v_mul_f32 v17, v13, v5
  v_sub_f32 v16, v16, v17
  v_mul_f32 v15, v15, v14
  v_mul_f32 v16, v16, v14
  v_mov_b32 v17, v11
  v_mov_b32 v18, v12
  v_mul_f32 v19, v17, v17
  v_mul_f32 v20, v18, v18
  v_sub_f32 v19, v19, v20
  v_mul_f32 v18, v17, v18
  v_add_f32 v18, v18, v18
  v_mov_b32 v17, v19
  v_mul_f32 v19, v17, v17
  v_mul_f32 v20, v18, v18
  v_sub_f32 v19, v19, v20
  v_mul_f32 v18, v17, v18
  v_add_f32 v18, v18, v18
  v_mov_b32 v17, v19
  v_mul_f32 v19, v17, v17
  v_mul_f32 v20, v18, v18
  v_sub_f32 v19, v19, v20
  v_mul_f32 v18, v17, v18
  v_add_f32 v18, v18, v18
  v_mov_b32 v17, v19
  v_mul_f32 v19, v17, v17
  v_mul_f32 v20, v18, v18
  v_sub_f32 v19, v19, v20
  v_mul_f32 v18, v17, v18
  v_add_f32 v18, v18, v18
  v_mov_b32 v17, v19
  v_mul_f32 v19, v17, v17
  v_mul_f32 v20, v18, v18
  v_sub_f32 v19, v19, v20
  v_mul_f32 v18, v17, v18
  v_add_f32 v18, v18, v18
  v_mov_b32 v17, v19
  v_lshlrev_b32 v2, 2, v1
  v_add_u32 v3, 0, v2
  buffer_store_dword v11, v3, s[12:15], s22 offen
  v_add_u32 v3, 2048, v2
  buffer_store_dword v12, v3, s[12:15], s22 offen
  v_add_u32 v3, 4096, v2
  buffer_store_dword v15, v3, s[12:15], s22 offen
  v_add_u32 v3, 6144, v2
  buffer_store_dword v16, v3, s[12:15], s22 offen
  v_add_u32 v3, 8192, v2
  buffer_store_dword v17, v3, s[12:15], s22 offen
  v_add_u32 v3, 10240, v2
  buffer_store_dword v18, v3, s[12:15], s22 offen
  s_branch ln_end
ln_pref:
  s_sub_u32 s22, s2, 513
  s_movk_i32 s23, 80
  s_mov_b32 s24, s22
  s_cmp_lt_u32 s22, 112
  s_cbranch_scc1 ln_pref_go
  s_sub_u32 s24, s22, 112
  s_lshr_b32 s23, s24, 3
  s_lshl_b32 s23, s23, 3
  s_add_u32 s23, s23, 24
  s_and_b32 s24, s24, 7
ln_pref_go:
  s_add_u32 s26, s0, s23
  s_addc_u32 s27, s1, 0
  s_load_dwordx2 s[16:17], s[26:27], 0
  s_lshl_b32 s24, s24, 16
  v_lshlrev_b32 v1, 4, v0
  s_waitcnt lgkmcnt(0)
  s_mov_b32 s8, s16
  s_mov_b32 s9, s17
  s_mov_b32 s10, 0x700000
  s_mov_b32 s11, 0x00020000
  s_add_u32 s25, s24, 0
  buffer_load_dwordx4 v[4:7], v1, s[8:11], s25 offen
  s_add_u32 s25, s24, 4096
  buffer_load_dwordx4 v[8:11], v1, s[8:11], s25 offen
  s_add_u32 s25, s24, 8192
  buffer_load_dwordx4 v[12:15], v1, s[8:11], s25 offen
  s_add_u32 s25, s24, 12288
  buffer_load_dwordx4 v[16:19], v1, s[8:11], s25 offen
  s_add_u32 s25, s24, 16384
  buffer_load_dwordx4 v[20:23], v1, s[8:11], s25 offen
  s_add_u32 s25, s24, 20480
  buffer_load_dwordx4 v[24:27], v1, s[8:11], s25 offen
  s_add_u32 s25, s24, 24576
  buffer_load_dwordx4 v[28:31], v1, s[8:11], s25 offen
  s_add_u32 s25, s24, 28672
  buffer_load_dwordx4 v[32:35], v1, s[8:11], s25 offen
  s_waitcnt vmcnt(0)
  s_add_u32 s25, s24, 32768
  buffer_load_dwordx4 v[4:7], v1, s[8:11], s25 offen
  s_add_u32 s25, s24, 36864
  buffer_load_dwordx4 v[8:11], v1, s[8:11], s25 offen
  s_add_u32 s25, s24, 40960
  buffer_load_dwordx4 v[12:15], v1, s[8:11], s25 offen
  s_add_u32 s25, s24, 45056
  buffer_load_dwordx4 v[16:19], v1, s[8:11], s25 offen
  s_add_u32 s25, s24, 49152
  buffer_load_dwordx4 v[20:23], v1, s[8:11], s25 offen
  s_add_u32 s25, s24, 53248
  buffer_load_dwordx4 v[24:27], v1, s[8:11], s25 offen
  s_add_u32 s25, s24, 57344
  buffer_load_dwordx4 v[28:31], v1, s[8:11], s25 offen
  s_add_u32 s25, s24, 61440
  buffer_load_dwordx4 v[32:35], v1, s[8:11], s25 offen
  s_waitcnt vmcnt(0)
ln_end:
  s_endpgm
.globl c1_kernel
.p2align 8
.type c1_kernel,@function
c1_kernel:
  s_cmp_ge_u32 s2, 384
  s_cbranch_scc1 c1_end
  s_cmp_ge_u32 s2, 256
  s_cbranch_scc1 c1_pref
  s_load_dwordx2 s[4:5], s[0:1], 24
  s_load_dwordx2 s[6:7], s[0:1], 32
  s_load_dwordx2 s[20:21], s[0:1], 128
  v_lshrrev_b32 v1, 6, v0
  s_nop 1
  v_readfirstlane_b32 s3, v1
  v_and_b32 v1, 63, v0
  v_lshrrev_b32 v2, 5, v1
  v_and_b32 v3, 31, v1
  s_nop 2
  s_lshl_b32 s40, s3, 11
  s_and_b32 s45, s2, 7
  s_lshr_b32 s46, s2, 3
  s_lshr_b32 s47, s3, 1
  s_and_b32 s48, s3, 1
  s_waitcnt lgkmcnt(0)
  s_mov_b32 s8, s4
  s_mov_b32 s9, s5
  s_mov_b32 s10, 0x80000
  s_mov_b32 s11, 0x00020000
  s_mov_b32 s12, s6
  s_mov_b32 s13, s7
  s_mov_b32 s14, 0x80000
  s_mov_b32 s15, 0x00020000
  s_mov_b32 s16, s20
  s_mov_b32 s17, s21
  s_mov_b32 s18, 0x10000000
  s_mov_b32 s19, 0x00020000
  s_lshl_b32 s49, s45, 6
  s_lshl_b32 s50, s48, 5
  s_add_u32 s49, s49, s50
  v_add_u32 v4, s49, v3
  v_lshlrev_b32 v118, 2, v4
  s_mov_b32 s51, 0x1400000
  v_add_u32 v5, 0, v118
  buffer_load_dword v110, v5, s[16:19], s51 offen
  v_add_u32 v5, 2048, v118
  buffer_load_dword v111, v5, s[16:19], s51 offen
  v_add_u32 v5, 4096, v118
  buffer_load_dword v112, v5, s[16:19], s51 offen
  v_add_u32 v5, 6144, v118
  buffer_load_dword v113, v5, s[16:19], s51 offen
  v_lshrrev_b32 v4, 3, v1
  v_lshl_add_u32 v4, s3, 4, v4
  v_lshrrev_b32 v5, 1, v4
  v_and_b32 v5, 7, v5
  v_and_b32 v6, 7, v1
  v_xor_b32 v5, v5, v6
  v_lshlrev_b32 v5, 4, v5
  s_mov_b32 s44, 1024
  v_mul_lo_u32 v4, v4, s44
  v_add_u32 v72, v4, v5
  v_lshrrev_b32 v4, 3, v1
  v_lshl_add_u32 v4, s3, 4, v4
  v_add_u32 v4, 8, v4
  v_lshrrev_b32 v5, 1, v4
  v_and_b32 v5, 7, v5
  v_and_b32 v6, 7, v1
  v_xor_b32 v5, v5, v6
  v_lshlrev_b32 v5, 4, v5
  s_mov_b32 s44, 1024
  v_mul_lo_u32 v4, v4, s44
  v_add_u32 v73, v4, v5
  v_subrev_u32 v73, 1024, v73
  v_lshrrev_b32 v4, 3, v1
  v_lshl_add_u32 v4, s3, 4, v4
  v_lshrrev_b32 v5, 1, v4
  v_and_b32 v5, 7, v5
  v_and_b32 v6, 7, v1
  v_xor_b32 v5, v5, v6
  v_lshlrev_b32 v5, 4, v5
  s_mov_b32 s44, 1024
  v_mul_lo_u32 v4, v4, s44
  v_add_u32 v74, v4, v5
  v_lshrrev_b32 v4, 3, v1
  v_lshl_add_u32 v4, s3, 4, v4
  v_add_u32 v4, 8, v4
  v_lshrrev_b32 v5, 1, v4
  v_and_b32 v5, 7, v5
  v_and_b32 v6, 7, v1
  v_xor_b32 v5, v5, v6
  v_lshlrev_b32 v5, 4, v5
  s_mov_b32 s44, 1024
  v_mul_lo_u32 v4, v4, s44
  v_add_u32 v75, v4, v5
  v_subrev_u32 v75, 1024, v75
  v_lshrrev_b32 v4, 3, v1
  v_lshl_add_u32 v4, s3, 4, v4
  v_lshrrev_b32 v5, 1, v4
  v_and_b32 v5, 7, v5
  v_and_b32 v6, 7, v1
  v_xor_b32 v5, v5, v6
  v_lshlrev_b32 v5, 4, v5
  s_mov_b32 s44, 1024
  v_mul_lo_u32 v4, v4, s44
  v_add_u32 v76, v4, v5
  v_lshrrev_b32 v4, 3, v1
  v_lshl_add_u32 v4, s3, 4, v4
  v_add_u32 v4, 8, v4
  v_lshrrev_b32 v5, 1, v4
  v_and_b32 v5, 7, v5
  v_and_b32 v6, 7, v1
  v_xor_b32 v5, v5, v6
  v_lshlrev_b32 v5, 4, v5
  s_mov_b32 s44, 1024
  v_mul_lo_u32 v4, v4, s44
  v_add_u32 v77, v4, v5
  v_subrev_u32 v77, 1024, v77
  v_lshl_add_u32 v4, s47, 5, v3
  v_lshrrev_b32 v5, 1, v4
  v_and_b32 v5, 7, v5
  v_lshlrev_b32 v4, 7, v4
  v_add_u32 v6, 0, v2
  v_xor_b32 v6, v6, v5
  v_lshl_add_u32 v84, v6, 4, v4
  v_add_u32 v6, 2, v2
  v_xor_b32 v6, v6, v5
  v_lshl_add_u32 v85, v6, 4, v4
  v_add_u32 v6, 4, v2
  v_xor_b32 v6, v6, v5
  v_lshl_add_u32 v86, v6, 4, v4
  v_add_u32 v6, 6, v2
  v_xor_b32 v6, v6, v5
  v_lshl_add_u32 v87, v6, 4, v4
  v_add_u32 v96, 0xa000, v84
  v_add_u32 v97, 0xa000, v85
  v_add_u32 v98, 0xa000, v86
  v_add_u32 v99, 0xa000, v87
  v_lshl_add_u32 v4, s48, 5, v3
  v_lshrrev_b32 v5, 1, v4
  v_and_b32 v5, 7, v5
  v_lshlrev_b32 v4, 7, v4
  v_add_u32 v6, 0, v2
  v_xor_b32 v6, v6, v5
  v_lshl_add_u32 v88, v6, 4, v4
  v_add_u32 v6, 2, v2
  v_xor_b32 v6, v6, v5
  v_lshl_add_u32 v89, v6, 4, v4
  v_add_u32 v6, 4, v2
  v_xor_b32 v6, v6, v5
  v_lshl_add_u32 v90, v6, 4, v4
  v_add_u32 v6, 6, v2
  v_xor_b32 v6, v6, v5
  v_lshl_add_u32 v91, v6, 4, v4
  v_add_u32 v100, 0xa000, v88
  v_add_u32 v101, 0xa000, v89
  v_add_u32 v102, 0xa000, v90
  v_add_u32 v103, 0xa000, v91
  s_lshl_b32 s32, s46, 16
  s_add_u32 s32, s32, 0x0
  s_lshl_b32 s33, s45, 16
  s_mov_b32 s34, s33
  v_mov_b32 v16, 0
  v_mov_b32 v17, 0
  v_mov_b32 v18, 0
  v_mov_b32 v19, 0
  v_mov_b32 v20, 0
  v_mov_b32 v21, 0
  v_mov_b32 v22, 0
  v_mov_b32 v23, 0
  v_mov_b32 v24, 0
  v_mov_b32 v25, 0
  v_mov_b32 v26, 0
  v_mov_b32 v27, 0
  v_mov_b32 v28, 0
  v_mov_b32 v29, 0
  v_mov_b32 v30, 0
  v_mov_b32 v31, 0
  v_mov_b32 v32, 0
  v_mov_b32 v33, 0
  v_mov_b32 v34, 0
  v_mov_b32 v35, 0
  v_mov_b32 v36, 0
  v_mov_b32 v37, 0
  v_mov_b32 v38, 0
  v_mov_b32 v39, 0
  v_mov_b32 v40, 0
  v_mov_b32 v41, 0
  v_mov_b32 v42, 0
  v_mov_b32 v43, 0
  v_mov_b32 v44, 0
  v_mov_b32 v45, 0
  v_mov_b32 v46, 0
  v_mov_b32 v47, 0
  s_add_u32 m0, s40, 0
  s_nop 0
  buffer_load_dwordx4 v72, s[16:19], s32 offen lds
  buffer_load_dwordx4 v73, s[16:19], s32 offen offset:1024 lds
  s_add_u32 s32, s32, 0x80
  s_add_u32 m0, s40, 8192
  s_nop 0
  buffer_load_dwordx4 v74, s[8:11], s33 offen lds
  buffer_load_dwordx4 v75, s[8:11], s33 offen offset:1024 lds
  s_add_u32 s33, s33, 0x80
  s_add_u32 m0, s40, 16384
  s_nop 0
  buffer_load_dwordx4 v76, s[12:15], s34 offen lds
  buffer_load_dwordx4 v77, s[12:15], s34 offen offset:1024 lds
  s_add_u32 s34, s34, 0x80
  s_add_u32 m0, s40, 24576
  s_nop 0
  buffer_load_dwordx4 v72, s[16:19], s32 offen lds
  buffer_load_dwordx4 v73, s[16:19], s32 offen offset:1024 lds
  s_add_u32 s32, s32, 0x80
  s_add_u32 m0, s40, 32768
  s_nop 0
  buffer_load_dwordx4 v74, s[8:11], s33 offen lds
  buffer_load_dwordx4 v75, s[8:11], s33 offen offset:1024 lds
  s_add_u32 s33, s33, 0x80
  s_add_u32 m0, s40, 40960
  s_nop 0
  buffer_load_dwordx4 v76, s[12:15], s34 offen lds
  buffer_load_dwordx4 v77, s[12:15], s34 offen offset:1024 lds
  s_add_u32 s34, s34, 0x80
  s_waitcnt vmcnt(6)
  s_barrier
  s_add_u32 m0, s40, 49152
  s_nop 0
  buffer_load_dwordx4 v72, s[16:19], s32 offen lds
  buffer_load_dwordx4 v73, s[16:19], s32 offen offset:1024 lds
  s_add_u32 s32, s32, 0x80
  s_add_u32 m0, s40, 57344
  s_nop 0
  buffer_load_dwordx4 v74, s[8:11], s33 offen lds
  buffer_load_dwordx4 v75, s[8:11], s33 offen offset:1024 lds
  s_add_u32 s33, s33, 0x80
  s_add_u32 m0, s40, 65536
  s_nop 0
  buffer_load_dwordx4 v76, s[12:15], s34 offen lds
  buffer_load_dwordx4 v77, s[12:15], s34 offen offset:1024 lds
  s_add_u32 s34, s34, 0x80
  ds_read_b128 v[48:51], v84 offset:0
  ds_read_b128 v[52:55], v88 offset:8192
  ds_read_b128 v[56:59], v88 offset:16384
  ds_read_b128 v[60:63], v85 offset:0
  ds_read_b128 v[64:67], v89 offset:8192
  ds_read_b128 v[68:71], v89 offset:16384
  s_waitcnt lgkmcnt(3)
  v_mfma_f32_32x32x16_bf16 v[16:31], v[48:51], v[52:55], v[16:31]
  v_mfma_f32_32x32x16_bf16 v[32:47], v[48:51], v[56:59], v[32:47]
  ds_read_b128 v[48:51], v86 offset:0
  ds_read_b128 v[52:55], v90 offset:8192
  ds_read_b128 v[56:59], v90 offset:16384
  s_waitcnt lgkmcnt(3)
  v_mfma_f32_32x32x16_bf16 v[16:31], v[60:63], v[64:67], v[16:31]
  v_mfma_f32_32x32x16_bf16 v[32:47], v[60:63], v[68:71], v[32:47]
  ds_read_b128 v[60:63], v87 offset:0
  ds_read_b128 v[64:67], v91 offset:8192
  ds_read_b128 v[68:71], v91 offset:16384
  s_waitcnt lgkmcnt(3)
  v_mfma_f32_32x32x16_bf16 v[16:31], v[48:51], v[52:55], v[16:31]
  v_mfma_f32_32x32x16_bf16 v[32:47], v[48:51], v[56:59], v[32:47]
  s_waitcnt lgkmcnt(0)
  v_mfma_f32_32x32x16_bf16 v[16:31], v[60:63], v[64:67], v[16:31]
  v_mfma_f32_32x32x16_bf16 v[32:47], v[60:63], v[68:71], v[32:47]
  s_waitcnt vmcnt(6)
  s_barrier
  s_add_u32 m0, s40, 0
  s_nop 0
  buffer_load_dwordx4 v72, s[16:19], s32 offen lds
  buffer_load_dwordx4 v73, s[16:19], s32 offen offset:1024 lds
  s_add_u32 s32, s32, 0x80
  s_add_u32 m0, s40, 8192
  s_nop 0
  buffer_load_dwordx4 v74, s[8:11], s33 offen lds
  buffer_load_dwordx4 v75, s[8:11], s33 offen offset:1024 lds
  s_add_u32 s33, s33, 0x80
  s_add_u32 m0, s40, 16384
  s_nop 0
  buffer_load_dwordx4 v76, s[12:15], s34 offen lds
  buffer_load_dwordx4 v77, s[12:15], s34 offen offset:1024 lds
  s_add_u32 s34, s34, 0x80
  ds_read_b128 v[48:51], v84 offset:24576
  ds_read_b128 v[52:55], v88 offset:32768
  ds_read_b128 v[56:59], v88 offset:40960
  ds_read_b128 v[60:63], v85 offset:24576
  ds_read_b128 v[64:67], v89 offset:32768
  ds_read_b128 v[68:71], v89 offset:40960
  s_waitcnt lgkmcnt(3)
  v_mfma_f32_32x32x16_bf16 v[16:31], v[48:51], v[52:55], v[16:31]
  v_mfma_f32_32x32x16_bf16 v[32:47], v[48:51], v[56:59], v[32:47]
  ds_read_b128 v[48:51], v86 offset:24576
  ds_read_b128 v[52:55], v90 offset:32768
  ds_read_b128 v[56:59], v90 offset:40960
  s_waitcnt lgkmcnt(3)
  v_mfma_f32_32x32x16_bf16 v[16:31], v[60:63], v[64:67], v[16:31]
  v_mfma_f32_32x32x16_bf16 v[32:47], v[60:63], v[68:71], v[32:47]
  ds_read_b128 v[60:63], v87 offset:24576
  ds_read_b128 v[64:67], v91 offset:32768
  ds_read_b128 v[68:71], v91 offset:40960
  s_waitcnt lgkmcnt(3)
  v_mfma_f32_32x32x16_bf16 v[16:31], v[48:51], v[52:55], v[16:31]
  v_mfma_f32_32x32x16_bf16 v[32:47], v[48:51], v[56:59], v[32:47]
  s_waitcnt lgkmcnt(0)
  v_mfma_f32_32x32x16_bf16 v[16:31], v[60:63], v[64:67], v[16:31]
  v_mfma_f32_32x32x16_bf16 v[32:47], v[60:63], v[68:71], v[32:47]
  s_waitcnt vmcnt(6)
  s_barrier
  s_add_u32 m0, s40, 24576
  s_nop 0
  buffer_load_dwordx4 v72, s[16:19], s32 offen lds
  buffer_load_dwordx4 v73, s[16:19], s32 offen offset:1024 lds
  s_add_u32 s32, s32, 0x80
  s_add_u32 m0, s40, 32768
  s_nop 0
  buffer_load_dwordx4 v74, s[8:11], s33 offen lds
  buffer_load_dwordx4 v75, s[8:11], s33 offen offset:1024 lds
  s_add_u32 s33, s33, 0x80
  s_add_u32 m0, s40, 40960
  s_nop 0
  buffer_load_dwordx4 v76, s[12:15], s34 offen lds
  buffer_load_dwordx4 v77, s[12:15], s34 offen offset:1024 lds
  s_add_u32 s34, s34, 0x80
  ds_read_b128 v[48:51], v84 offset:49152
  ds_read_b128 v[52:55], v88 offset:57344
  ds_read_b128 v[56:59], v100 offset:24576
  ds_read_b128 v[60:63], v85 offset:49152
  ds_read_b128 v[64:67], v89 offset:57344
  ds_read_b128 v[68:71], v101 offset:24576
  s_waitcnt lgkmcnt(3)
  v_mfma_f32_32x32x16_bf16 v[16:31], v[48:51], v[52:55], v[16:31]
  v_mfma_f32_32x32x16_bf16 v[32:47], v[48:51], v[56:59], v[32:47]
  ds_read_b128 v[48:51], v86 offset:49152
  ds_read_b128 v[52:55], v90 offset:57344
  ds_read_b128 v[56:59], v102 offset:24576
  s_waitcnt lgkmcnt(3)
  v_mfma_f32_32x32x16_bf16 v[16:31], v[60:63], v[64:67], v[16:31]
  v_mfma_f32_32x32x16_bf16 v[32:47], v[60:63], v[68:71], v[32:47]
  ds_read_b128 v[60:63], v87 offset:49152
  ds_read_b128 v[64:67], v91 offset:57344
  ds_read_b128 v[68:71], v103 offset:24576
  s_waitcnt lgkmcnt(3)
  v_mfma_f32_32x32x16_bf16 v[16:31], v[48:51], v[52:55], v[16:31]
  v_mfma_f32_32x32x16_bf16 v[32:47], v[48:51], v[56:59], v[32:47]
  s_waitcnt lgkmcnt(0)
  v_mfma_f32_32x32x16_bf16 v[16:31], v[60:63], v[64:67], v[16:31]
  v_mfma_f32_32x32x16_bf16 v[32:47], v[60:63], v[68:71], v[32:47]
  s_waitcnt vmcnt(6)
  s_barrier
  s_add_u32 m0, s40, 49152
  s_nop 0
  buffer_load_dwordx4 v72, s[16:19], s32 offen lds
  buffer_load_dwordx4 v73, s[16:19], s32 offen offset:1024 lds
  s_add_u32 s32, s32, 0x80
  s_add_u32 m0, s40, 57344
  s_nop 0
  buffer_load_dwordx4 v74, s[8:11], s33 offen lds
  buffer_load_dwordx4 v75, s[8:11], s33 offen offset:1024 lds
  s_add_u32 s33, s33, 0x80
  s_add_u32 m0, s40, 65536
  s_nop 0
  buffer_load_dwordx4 v76, s[12:15], s34 offen lds
  buffer_load_dwordx4 v77, s[12:15], s34 offen offset:1024 lds
  s_add_u32 s34, s34, 0x80
  ds_read_b128 v[48:51], v84 offset:0
  ds_read_b128 v[52:55], v88 offset:8192
  ds_read_b128 v[56:59], v88 offset:16384
  ds_read_b128 v[60:63], v85 offset:0
  ds_read_b128 v[64:67], v89 offset:8192
  ds_read_b128 v[68:71], v89 offset:16384
  s_waitcnt lgkmcnt(3)
  v_mfma_f32_32x32x16_bf16 v[16:31], v[48:51], v[52:55], v[16:31]
  v_mfma_f32_32x32x16_bf16 v[32:47], v[48:51], v[56:59], v[32:47]
  ds_read_b128 v[48:51], v86 offset:0
  ds_read_b128 v[52:55], v90 offset:8192
  ds_read_b128 v[56:59], v90 offset:16384
  s_waitcnt lgkmcnt(3)
  v_mfma_f32_32x32x16_bf16 v[16:31], v[60:63], v[64:67], v[16:31]
  v_mfma_f32_32x32x16_bf16 v[32:47], v[60:63], v[68:71], v[32:47]
  ds_read_b128 v[60:63], v87 offset:0
  ds_read_b128 v[64:67], v91 offset:8192
  ds_read_b128 v[68:71], v91 offset:16384
  s_waitcnt lgkmcnt(3)
  v_mfma_f32_32x32x16_bf16 v[16:31], v[48:51], v[52:55], v[16:31]
  v_mfma_f32_32x32x16_bf16 v[32:47], v[48:51], v[56:59], v[32:47]
  s_waitcnt lgkmcnt(0)
  v_mfma_f32_32x32x16_bf16 v[16:31], v[60:63], v[64:67], v[16:31]
  v_mfma_f32_32x32x16_bf16 v[32:47], v[60:63], v[68:71], v[32:47]
  s_waitcnt vmcnt(6)
  s_barrier
  s_add_u32 m0, s40, 0
  s_nop 0
  buffer_load_dwordx4 v72, s[16:19], s32 offen lds
  buffer_load_dwordx4 v73, s[16:19], s32 offen offset:1024 lds
  s_add_u32 s32, s32, 0x80
  s_add_u32 m0, s40, 8192
  s_nop 0
  buffer_load_dwordx4 v74, s[8:11], s33 offen lds
  buffer_load_dwordx4 v75, s[8:11], s33 offen offset:1024 lds
  s_add_u32 s33, s33, 0x80
  s_add_u32 m0, s40, 16384
  s_nop 0
  buffer_load_dwordx4 v76, s[12:15], s34 offen lds
  buffer_load_dwordx4 v77, s[12:15], s34 offen offset:1024 lds
  s_add_u32 s34, s34, 0x80
  ds_read_b128 v[48:51], v84 offset:24576
  ds_read_b128 v[52:55], v88 offset:32768
  ds_read_b128 v[56:59], v88 offset:40960
  ds_read_b128 v[60:63], v85 offset:24576
  ds_read_b128 v[64:67], v89 offset:32768
  ds_read_b128 v[68:71], v89 offset:40960
  s_waitcnt lgkmcnt(3)
  v_mfma_f32_32x32x16_bf16 v[16:31], v[48:51], v[52:55], v[16:31]
  v_mfma_f32_32x32x16_bf16 v[32:47], v[48:51], v[56:59], v[32:47]
  ds_read_b128 v[48:51], v86 offset:24576
  ds_read_b128 v[52:55], v90 offset:32768
  ds_read_b128 v[56:59], v90 offset:40960
  s_waitcnt lgkmcnt(3)
  v_mfma_f32_32x32x16_bf16 v[16:31], v[60:63], v[64:67], v[16:31]
  v_mfma_f32_32x32x16_bf16 v[32:47], v[60:63], v[68:71], v[32:47]
  ds_read_b128 v[60:63], v87 offset:24576
  ds_read_b128 v[64:67], v91 offset:32768
  ds_read_b128 v[68:71], v91 offset:40960
  s_waitcnt lgkmcnt(3)
  v_mfma_f32_32x32x16_bf16 v[16:31], v[48:51], v[52:55], v[16:31]
  v_mfma_f32_32x32x16_bf16 v[32:47], v[48:51], v[56:59], v[32:47]
  s_waitcnt lgkmcnt(0)
  v_mfma_f32_32x32x16_bf16 v[16:31], v[60:63], v[64:67], v[16:31]
  v_mfma_f32_32x32x16_bf16 v[32:47], v[60:63], v[68:71], v[32:47]
  s_waitcnt vmcnt(6)
  s_barrier
  s_add_u32 m0, s40, 24576
  s_nop 0
  buffer_load_dwordx4 v72, s[16:19], s32 offen lds
  buffer_load_dwordx4 v73, s[16:19], s32 offen offset:1024 lds
  s_add_u32 s32, s32, 0x80
  s_add_u32 m0, s40, 32768
  s_nop 0
  buffer_load_dwordx4 v74, s[8:11], s33 offen lds
  buffer_load_dwordx4 v75, s[8:11], s33 offen offset:1024 lds
  s_add_u32 s33, s33, 0x80
  s_add_u32 m0, s40, 40960
  s_nop 0
  buffer_load_dwordx4 v76, s[12:15], s34 offen lds
  buffer_load_dwordx4 v77, s[12:15], s34 offen offset:1024 lds
  s_add_u32 s34, s34, 0x80
  ds_read_b128 v[48:51], v84 offset:49152
  ds_read_b128 v[52:55], v88 offset:57344
  ds_read_b128 v[56:59], v100 offset:24576
  ds_read_b128 v[60:63], v85 offset:49152
  ds_read_b128 v[64:67], v89 offset:57344
  ds_read_b128 v[68:71], v101 offset:24576
  s_waitcnt lgkmcnt(3)
  v_mfma_f32_32x32x16_bf16 v[16:31], v[48:51], v[52:55], v[16:31]
  v_mfma_f32_32x32x16_bf16 v[32:47], v[48:51], v[56:59], v[32:47]
  ds_read_b128 v[48:51], v86 offset:49152
  ds_read_b128 v[52:55], v90 offset:57344
  ds_read_b128 v[56:59], v102 offset:24576
  s_waitcnt lgkmcnt(3)
  v_mfma_f32_32x32x16_bf16 v[16:31], v[60:63], v[64:67], v[16:31]
  v_mfma_f32_32x32x16_bf16 v[32:47], v[60:63], v[68:71], v[32:47]
  ds_read_b128 v[60:63], v87 offset:49152
  ds_read_b128 v[64:67], v91 offset:57344
  ds_read_b128 v[68:71], v103 offset:24576
  s_waitcnt lgkmcnt(3)
  v_mfma_f32_32x32x16_bf16 v[16:31], v[48:51], v[52:55], v[16:31]
  v_mfma_f32_32x32x16_bf16 v[32:47], v[48:51], v[56:59], v[32:47]
  s_waitcnt lgkmcnt(0)
  v_mfma_f32_32x32x16_bf16 v[16:31], v[60:63], v[64:67], v[16:31]
  v_mfma_f32_32x32x16_bf16 v[32:47], v[60:63], v[68:71], v[32:47]
  s_waitcnt vmcnt(6)
  s_barrier
  ds_read_b128 v[48:51], v84 offset:0
  ds_read_b128 v[52:55], v88 offset:8192
  ds_read_b128 v[56:59], v88 offset:16384
  ds_read_b128 v[60:63], v85 offset:0
  ds_read_b128 v[64:67], v89 offset:8192
  ds_read_b128 v[68:71], v89 offset:16384
  s_waitcnt lgkmcnt(3)
  v_mfma_f32_32x32x16_bf16 v[16:31], v[48:51], v[52:55], v[16:31]
  v_mfma_f32_32x32x16_bf16 v[32:47], v[48:51], v[56:59], v[32:47]
  ds_read_b128 v[48:51], v86 offset:0
  ds_read_b128 v[52:55], v90 offset:8192
  ds_read_b128 v[56:59], v90 offset:16384
  s_waitcnt lgkmcnt(3)
  v_mfma_f32_32x32x16_bf16 v[16:31], v[60:63], v[64:67], v[16:31]
  v_mfma_f32_32x32x16_bf16 v[32:47], v[60:63], v[68:71], v[32:47]
  ds_read_b128 v[60:63], v87 offset:0
  ds_read_b128 v[64:67], v91 offset:8192
  ds_read_b128 v[68:71], v91 offset:16384
  s_waitcnt lgkmcnt(3)
  v_mfma_f32_32x32x16_bf16 v[16:31], v[48:51], v[52:55], v[16:31]
  v_mfma_f32_32x32x16_bf16 v[32:47], v[48:51], v[56:59], v[32:47]
  s_waitcnt lgkmcnt(0)
  v_mfma_f32_32x32x16_bf16 v[16:31], v[60:63], v[64:67], v[16:31]
  v_mfma_f32_32x32x16_bf16 v[32:47], v[60:63], v[68:71], v[32:47]
  s_waitcnt vmcnt(0)
  s_barrier
  ds_read_b128 v[48:51], v84 offset:24576
  ds_read_b128 v[52:55], v88 offset:32768
  ds_read_b128 v[56:59], v88 offset:40960
  ds_read_b128 v[60:63], v85 offset:24576
  ds_read_b128 v[64:67], v89 offset:32768
  ds_read_b128 v[68:71], v89 offset:40960
  s_waitcnt lgkmcnt(3)
  v_mfma_f32_32x32x16_bf16 v[16:31], v[48:51], v[52:55], v[16:31]
  v_mfma_f32_32x32x16_bf16 v[32:47], v[48:51], v[56:59], v[32:47]
  ds_read_b128 v[48:51], v86 offset:24576
  ds_read_b128 v[52:55], v90 offset:32768
  ds_read_b128 v[56:59], v90 offset:40960
  s_waitcnt lgkmcnt(3)
  v_mfma_f32_32x32x16_bf16 v[16:31], v[60:63], v[64:67], v[16:31]
  v_mfma_f32_32x32x16_bf16 v[32:47], v[60:63], v[68:71], v[32:47]
  ds_read_b128 v[60:63], v87 offset:24576
  ds_read_b128 v[64:67], v91 offset:32768
  ds_read_b128 v[68:71], v91 offset:40960
  s_waitcnt lgkmcnt(3)
  v_mfma_f32_32x32x16_bf16 v[16:31], v[48:51], v[52:55], v[16:31]
  v_mfma_f32_32x32x16_bf16 v[32:47], v[48:51], v[56:59], v[32:47]
  s_waitcnt lgkmcnt(0)
  v_mfma_f32_32x32x16_bf16 v[16:31], v[60:63], v[64:67], v[16:31]
  v_mfma_f32_32x32x16_bf16 v[32:47], v[60:63], v[68:71], v[32:47]
  s_nop 15
  s_nop 7
  v_mul_f32 v119, v112, v16
  v_mul_f32 v120, v112, v32
  v_fmac_f32 v120, v113, v16
  v_fma_f32 v16, -v113, v32, v119
  v_mov_b32 v32, v120
  v_mul_f32 v119, v112, v17
  v_mul_f32 v120, v112, v33
  v_fmac_f32 v120, v113, v17
  v_fma_f32 v17, -v113, v33, v119
  v_mov_b32 v33, v120
  v_mul_f32 v119, v112, v18
  v_mul_f32 v120, v112, v34
  v_fmac_f32 v120, v113, v18
  v_fma_f32 v18, -v113, v34, v119
  v_mov_b32 v34, v120
  v_mul_f32 v119, v112, v19
  v_mul_f32 v120, v112, v35
  v_fmac_f32 v120, v113, v19
  v_fma_f32 v19, -v113, v35, v119
  v_mov_b32 v35, v120
  v_mul_f32 v119, v112, v20
  v_mul_f32 v120, v112, v36
  v_fmac_f32 v120, v113, v20
  v_fma_f32 v20, -v113, v36, v119
  v_mov_b32 v36, v120
  v_mul_f32 v119, v112, v21
  v_mul_f32 v120, v112, v37
  v_fmac_f32 v120, v113, v21
  v_fma_f32 v21, -v113, v37, v119
  v_mov_b32 v37, v120
  v_mul_f32 v119, v112, v22
  v_mul_f32 v120, v112, v38
  v_fmac_f32 v120, v113, v22
  v_fma_f32 v22, -v113, v38, v119
  v_mov_b32 v38, v120
  v_mul_f32 v119, v112, v23
  v_mul_f32 v120, v112, v39
  v_fmac_f32 v120, v113, v23
  v_fma_f32 v23, -v113, v39, v119
  v_mov_b32 v39, v120
  v_mul_f32 v119, v112, v24
  v_mul_f32 v120, v112, v40
  v_fmac_f32 v120, v113, v24
  v_fma_f32 v24, -v113, v40, v119
  v_mov_b32 v40, v120
  v_mul_f32 v119, v112, v25
  v_mul_f32 v120, v112, v41
  v_fmac_f32 v120, v113, v25
  v_fma_f32 v25, -v113, v41, v119
  v_mov_b32 v41, v120
  v_mul_f32 v119, v112, v26
  v_mul_f32 v120, v112, v42
  v_fmac_f32 v120, v113, v26
  v_fma_f32 v26, -v113, v42, v119
  v_mov_b32 v42, v120
  v_mul_f32 v119, v112, v27
  v_mul_f32 v120, v112, v43
  v_fmac_f32 v120, v113, v27
  v_fma_f32 v27, -v113, v43, v119
  v_mov_b32 v43, v120
  v_mul_f32 v119, v112, v28
  v_mul_f32 v120, v112, v44
  v_fmac_f32 v120, v113, v28
  v_fma_f32 v28, -v113, v44, v119
  v_mov_b32 v44, v120
  v_mul_f32 v119, v112, v29
  v_mul_f32 v120, v112, v45
  v_fmac_f32 v120, v113, v29
  v_fma_f32 v29, -v113, v45, v119
  v_mov_b32 v45, v120
  v_mul_f32 v119, v112, v30
  v_mul_f32 v120, v112, v46
  v_fmac_f32 v120, v113, v30
  v_fma_f32 v30, -v113, v46, v119
  v_mov_b32 v46, v120
  v_mul_f32 v119, v112, v31
  v_mul_f32 v120, v112, v47
  v_fmac_f32 v120, v113, v31
  v_fma_f32 v31, -v113, v47, v119
  v_mov_b32 v47, v120
  s_lshl_b32 s52, s46, 6
  s_lshl_b32 s53, s47, 5
  s_add_u32 s52, s52, s53
  v_lshl_add_u32 v4, v2, 2, s52
  v_lshl_add_u32 v4, v4, 11, v118
  s_mov_b32 s54, 0x600000
  s_mov_b32 s55, 0xa00000
  v_add_u32 v5, 0x0, v4
  buffer_store_dword v16, v5, s[16:19], s54 offen
  buffer_store_dword v32, v5, s[16:19], s55 offen
  v_add_u32 v5, 0x800, v4
  buffer_store_dword v17, v5, s[16:19], s54 offen
  buffer_store_dword v33, v5, s[16:19], s55 offen
  v_add_u32 v5, 0x1000, v4
  buffer_store_dword v18, v5, s[16:19], s54 offen
  buffer_store_dword v34, v5, s[16:19], s55 offen
  v_add_u32 v5, 0x1800, v4
  buffer_store_dword v19, v5, s[16:19], s54 offen
  buffer_store_dword v35, v5, s[16:19], s55 offen
  v_add_u32 v5, 0x4000, v4
  buffer_store_dword v20, v5, s[16:19], s54 offen
  buffer_store_dword v36, v5, s[16:19], s55 offen
  v_add_u32 v5, 0x4800, v4
  buffer_store_dword v21, v5, s[16:19], s54 offen
  buffer_store_dword v37, v5, s[16:19], s55 offen
  v_add_u32 v5, 0x5000, v4
  buffer_store_dword v22, v5, s[16:19], s54 offen
  buffer_store_dword v38, v5, s[16:19], s55 offen
  v_add_u32 v5, 0x5800, v4
  buffer_store_dword v23, v5, s[16:19], s54 offen
  buffer_store_dword v39, v5, s[16:19], s55 offen
  v_add_u32 v5, 0x8000, v4
  buffer_store_dword v24, v5, s[16:19], s54 offen
  buffer_store_dword v40, v5, s[16:19], s55 offen
  v_add_u32 v5, 0x8800, v4
  buffer_store_dword v25, v5, s[16:19], s54 offen
  buffer_store_dword v41, v5, s[16:19], s55 offen
  v_add_u32 v5, 0x9000, v4
  buffer_store_dword v26, v5, s[16:19], s54 offen
  buffer_store_dword v42, v5, s[16:19], s55 offen
  v_add_u32 v5, 0x9800, v4
  buffer_store_dword v27, v5, s[16:19], s54 offen
  buffer_store_dword v43, v5, s[16:19], s55 offen
  v_add_u32 v5, 0xc000, v4
  buffer_store_dword v28, v5, s[16:19], s54 offen
  buffer_store_dword v44, v5, s[16:19], s55 offen
  v_add_u32 v5, 0xc800, v4
  buffer_store_dword v29, v5, s[16:19], s54 offen
  buffer_store_dword v45, v5, s[16:19], s55 offen
  v_add_u32 v5, 0xd000, v4
  buffer_store_dword v30, v5, s[16:19], s54 offen
  buffer_store_dword v46, v5, s[16:19], s55 offen
  v_add_u32 v5, 0xd800, v4
  buffer_store_dword v31, v5, s[16:19], s54 offen
  buffer_store_dword v47, v5, s[16:19], s55 offen
  v_mul_f32 v119, v110, v110
  v_mul_f32 v120, v110, v111
  v_fma_f32 v119, -v111, v111, v119
  v_fmac_f32 v120, v111, v110
  v_mov_b32 v121, v119
  v_mov_b32 v122, v120
  v_mul_f32 v119, v121, v121
  v_mul_f32 v120, v121, v122
  v_fma_f32 v119, -v122, v122, v119
  v_fmac_f32 v120, v122, v121
  v_mov_b32 v123, v119
  v_mov_b32 v124, v120
  v_mul_f32 v119, v123, v110
  v_mul_f32 v120, v123, v111
  v_fma_f32 v119, -v124, v111, v119
  v_fmac_f32 v120, v124, v110
  v_mov_b32 v125, v119
  v_mov_b32 v126, v120
  v_mov_b32 v128, v16
  v_mov_b32 v129, v32
  v_fma_f32 v119, v110, v128, v17
  v_fma_f32 v120, v110, v129, v33
  v_fma_f32 v119, -v111, v129, v119
  v_fma_f32 v129, v111, v128, v120
  v_mov_b32 v128, v119
  v_fma_f32 v119, v110, v128, v18
  v_fma_f32 v120, v110, v129, v34
  v_fma_f32 v119, -v111, v129, v119
  v_fma_f32 v129, v111, v128, v120
  v_mov_b32 v128, v119
  v_fma_f32 v119, v110, v128, v19
  v_fma_f32 v120, v110, v129, v35
  v_fma_f32 v119, -v111, v129, v119
  v_fma_f32 v129, v111, v128, v120
  v_mov_b32 v128, v119
  v_fma_f32 v119, v125, v128, v20
  v_fma_f32 v120, v125, v129, v36
  v_fma_f32 v119, -v126, v129, v119
  v_fma_f32 v129, v126, v128, v120
  v_mov_b32 v128, v119
  v_fma_f32 v119, v110, v128, v21
  v_fma_f32 v120, v110, v129, v37
  v_fma_f32 v119, -v111, v129, v119
  v_fma_f32 v129, v111, v128, v120
  v_mov_b32 v128, v119
  v_fma_f32 v119, v110, v128, v22
  v_fma_f32 v120, v110, v129, v38
  v_fma_f32 v119, -v111, v129, v119
  v_fma_f32 v129, v111, v128, v120
  v_mov_b32 v128, v119
  v_fma_f32 v119, v110, v128, v23
  v_fma_f32 v120, v110, v129, v39
  v_fma_f32 v119, -v111, v129, v119
  v_fma_f32 v129, v111, v128, v120
  v_mov_b32 v128, v119
  v_fma_f32 v119, v125, v128, v24
  v_fma_f32 v120, v125, v129, v40
  v_fma_f32 v119, -v126, v129, v119
  v_fma_f32 v129, v126, v128, v120
  v_mov_b32 v128, v119
  v_fma_f32 v119, v110, v128, v25
  v_fma_f32 v120, v110, v129, v41
  v_fma_f32 v119, -v111, v129, v119
  v_fma_f32 v129, v111, v128, v120
  v_mov_b32 v128, v119
  v_fma_f32 v119, v110, v128, v26
  v_fma_f32 v120, v110, v129, v42
  v_fma_f32 v119, -v111, v129, v119
  v_fma_f32 v129, v111, v128, v120
  v_mov_b32 v128, v119
  v_fma_f32 v119, v110, v128, v27
  v_fma_f32 v120, v110, v129, v43
  v_fma_f32 v119, -v111, v129, v119
  v_fma_f32 v129, v111, v128, v120
  v_mov_b32 v128, v119
  v_fma_f32 v119, v125, v128, v28
  v_fma_f32 v120, v125, v129, v44
  v_fma_f32 v119, -v126, v129, v119
  v_fma_f32 v129, v126, v128, v120
  v_mov_b32 v128, v119
  v_fma_f32 v119, v110, v128, v29
  v_fma_f32 v120, v110, v129, v45
  v_fma_f32 v119, -v111, v129, v119
  v_fma_f32 v129, v111, v128, v120
  v_mov_b32 v128, v119
  v_fma_f32 v119, v110, v128, v30
  v_fma_f32 v120, v110, v129, v46
  v_fma_f32 v119, -v111, v129, v119
  v_fma_f32 v129, v111, v128, v120
  v_mov_b32 v128, v119
  v_fma_f32 v119, v110, v128, v31
  v_fma_f32 v120, v110, v129, v47
  v_fma_f32 v119, -v111, v129, v119
  v_fma_f32 v129, v111, v128, v120
  v_mov_b32 v128, v119
  v_mul_f32 v119, v128, v123
  v_mul_f32 v120, v128, v124
  v_fma_f32 v119, -v129, v124, v119
  v_fmac_f32 v120, v129, v123
  v_mov_b32 v130, v119
  v_mov_b32 v131, v120
  v_cmp_eq_u32 vcc, 0, v2
  s_nop 3
  v_cndmask_b32 v128, v128, v130, vcc
  v_cndmask_b32 v129, v129, v131, vcc
  s_lshl_b32 s52, s46, 1
  s_add_u32 s52, s52, s47
  s_lshl_b32 s52, s52, 1
  v_add_u32 v4, s52, v2
  v_lshlrev_b32 v4, 12, v4
  v_lshl_add_u32 v4, v118, 1, v4
  s_mov_b32 s54, 0xe00000
  buffer_store_dwordx2 v[128:129], v4, s[16:19], s54 offen
  s_branch c1_end
c1_pref:
  s_sub_u32 s22, s2, 256
  s_movk_i32 s23, 96
  s_mov_b32 s24, s22
  s_cmp_lt_u32 s22, 112
  s_cbranch_scc1 c1_pref_go
  s_sub_u32 s24, s22, 112
  s_lshr_b32 s23, s24, 3
  s_lshl_b32 s23, s23, 3
  s_add_u32 s23, s23, 40
  s_and_b32 s24, s24, 7
c1_pref_go:
  s_add_u32 s26, s0, s23
  s_addc_u32 s27, s1, 0
  s_load_dwordx2 s[16:17], s[26:27], 0
  s_lshl_b32 s24, s24, 16
  v_lshlrev_b32 v1, 4, v0
  s_waitcnt lgkmcnt(0)
  s_mov_b32 s8, s16
  s_mov_b32 s9, s17
  s_mov_b32 s10, 0x700000
  s_mov_b32 s11, 0x00020000
  s_add_u32 s25, s24, 0
  buffer_load_dwordx4 v[4:7], v1, s[8:11], s25 offen
  s_add_u32 s25, s24, 4096
  buffer_load_dwordx4 v[8:11], v1, s[8:11], s25 offen
  s_add_u32 s25, s24, 8192
  buffer_load_dwordx4 v[12:15], v1, s[8:11], s25 offen
  s_add_u32 s25, s24, 12288
  buffer_load_dwordx4 v[16:19], v1, s[8:11], s25 offen
  s_add_u32 s25, s24, 16384
  buffer_load_dwordx4 v[20:23], v1, s[8:11], s25 offen
  s_add_u32 s25, s24, 20480
  buffer_load_dwordx4 v[24:27], v1, s[8:11], s25 offen
  s_add_u32 s25, s24, 24576
  buffer_load_dwordx4 v[28:31], v1, s[8:11], s25 offen
  s_add_u32 s25, s24, 28672
  buffer_load_dwordx4 v[32:35], v1, s[8:11], s25 offen
  s_waitcnt vmcnt(0)
  s_add_u32 s25, s24, 32768
  buffer_load_dwordx4 v[4:7], v1, s[8:11], s25 offen
  s_add_u32 s25, s24, 36864
  buffer_load_dwordx4 v[8:11], v1, s[8:11], s25 offen
  s_add_u32 s25, s24, 40960
  buffer_load_dwordx4 v[12:15], v1, s[8:11], s25 offen
  s_add_u32 s25, s24, 45056
  buffer_load_dwordx4 v[16:19], v1, s[8:11], s25 offen
  s_add_u32 s25, s24, 49152
  buffer_load_dwordx4 v[20:23], v1, s[8:11], s25 offen
  s_add_u32 s25, s24, 53248
  buffer_load_dwordx4 v[24:27], v1, s[8:11], s25 offen
  s_add_u32 s25, s24, 57344
  buffer_load_dwordx4 v[28:31], v1, s[8:11], s25 offen
  s_add_u32 s25, s24, 61440
  buffer_load_dwordx4 v[32:35], v1, s[8:11], s25 offen
  s_waitcnt vmcnt(0)
c1_end:
  s_endpgm
.globl mid_kernel
.p2align 8
.type mid_kernel,@function
mid_kernel:
  s_cmp_ge_u32 s2, 352
  s_cbranch_scc1 mid_end
  s_cmp_lt_u32 s2, 128
  s_cbranch_scc1 mid_scan
  s_sub_u32 s2, s2, 128
  s_load_dwordx2 s[4:5], s[0:1], 80
  s_load_dwordx2 s[6:7], s[0:1], 88
  s_load_dwordx2 s[20:21], s[0:1], 128
  v_lshrrev_b32 v1, 6, v0
  s_nop 1
  v_readfirstlane_b32 s3, v1
  v_and_b32 v1, 63, v0
  v_lshrrev_b32 v2, 5, v1
  v_and_b32 v3, 31, v1
  s_nop 2
  s_lshl_b32 s40, s3, 11
  s_and_b32 s45, s2, 7
  s_lshr_b32 s46, s2, 3
  s_mul_i32 s47, s46, 37
  s_lshr_b32 s47, s47, 8
  s_mul_i32 s48, s47, 7
  s_sub_u32 s48, s46, s48
  s_lshr_b32 s49, s45, 2
  s_lshl_b32 s49, s49, 2
  s_add_u32 s49, s49, s47
  s_and_b32 s50, s45, 3
  s_mul_i32 s50, s50, 7
  s_add_u32 s50, s50, s48
  s_lshr_b32 s47, s3, 1
  s_and_b32 s48, s3, 1
  s_waitcnt lgkmcnt(0)
  s_mov_b32 s8, s4
  s_mov_b32 s9, s5
  s_mov_b32 s10, 0x700000
  s_mov_b32 s11, 0x00020000
  s_mov_b32 s12, s6
  s_mov_b32 s13, s7
  s_mov_b32 s14, 0xe00
  s_mov_b32 s15, 0x00020000
  s_mov_b32 s16, s20
  s_mov_b32 s17, s21
  s_mov_b32 s18, 0x10000000
  s_mov_b32 s19, 0x00020000
  s_lshl_b32 s51, s50, 6
  s_lshl_b32 s52, s48, 5
  s_add_u32 s51, s51, s52
  v_add_u32 v4, s51, v3
  v_lshlrev_b32 v111, 1, v4
  buffer_load_ushort v110, v111, s[12:15], 0 offen
  v_lshrrev_b32 v4, 3, v1
  v_lshl_add_u32 v4, s3, 4, v4
  v_lshrrev_b32 v5, 1, v4
  v_and_b32 v5, 1, v5
  v_lshlrev_b32 v5, 2, v5
  v_and_b32 v6, 7, v1
  v_xor_b32 v5, v5, v6
  v_lshlrev_b32 v5, 4, v5
  s_mov_b32 s44, 1024
  v_mul_lo_u32 v4, v4, s44
  v_add_u32 v72, v4, v5
  v_lshrrev_b32 v4, 3, v1
  v_lshl_add_u32 v4, s3, 4, v4
  v_add_u32 v4, 8, v4
  v_lshrrev_b32 v5, 1, v4
  v_and_b32 v5, 1, v5
  v_lshlrev_b32 v5, 2, v5
  v_and_b32 v6, 7, v1
  v_xor_b32 v5, v5, v6
  v_lshlrev_b32 v5, 4, v5
  s_mov_b32 s44, 1024
  v_mul_lo_u32 v4, v4, s44
  v_add_u32 v73, v4, v5
  v_subrev_u32 v73, 1024, v73
  v_lshrrev_b32 v4, 3, v1
  v_lshl_add_u32 v4, s3, 4, v4
  v_lshrrev_b32 v5, 1, v4
  v_and_b32 v5, 1, v5
  v_lshlrev_b32 v5, 2, v5
  v_and_b32 v6, 7, v1
  v_xor_b32 v5, v5, v6
  v_lshlrev_b32 v5, 4, v5
  s_mov_b32 s44, 3584
  v_mul_lo_u32 v4, v4, s44
  v_add_u32 v74, v4, v5
  v_lshrrev_b32 v4, 3, v1
  v_lshl_add_u32 v4, s3, 4, v4
  v_add_u32 v4, 8, v4
  v_lshrrev_b32 v5, 1, v4
  v_and_b32 v5, 1, v5
  v_lshlrev_b32 v5, 2, v5
  v_and_b32 v6, 7, v1
  v_xor_b32 v5, v5, v6
  v_lshlrev_b32 v5, 4, v5
  s_mov_b32 s44, 3584
  v_mul_lo_u32 v4, v4, s44
  v_add_u32 v75, v4, v5
  v_subrev_u32 v75, 1024, v75
  v_and_b32 v4, 15, v1
  v_lshrrev_b32 v4, 2, v4
  v_lshl_add_u32 v5, v2, 3, v4
  v_lshlrev_b32 v5, 7, v5
  v_lshrrev_b32 v6, 1, v4
  v_and_b32 v6, 1, v6
  v_lshlrev_b32 v6, 2, v6
  v_lshrrev_b32 v7, 4, v1
  v_and_b32 v7, 1, v7
  v_lshlrev_b32 v7, 1, v7
  v_lshl_add_u32 v7, s47, 2, v7
  v_and_b32 v8, 3, v1
  v_lshrrev_b32 v9, 1, v8
  v_add_u32 v7, v7, v9
  v_xor_b32 v7, v7, v6
  v_lshl_add_u32 v5, v7, 4, v5
  v_and_b32 v8, 1, v8
  v_lshl_add_u32 v84, v8, 3, v5
  v_add_u32 v96, 0x10000, v84
  v_and_b32 v4, 15, v1
  v_lshrrev_b32 v4, 2, v4
  v_lshl_add_u32 v5, v2, 3, v4
  v_lshlrev_b32 v5, 7, v5
  v_lshrrev_b32 v6, 1, v4
  v_and_b32 v6, 1, v6
  v_lshlrev_b32 v6, 2, v6
  v_lshrrev_b32 v7, 4, v1
  v_and_b32 v7, 1, v7
  v_lshlrev_b32 v7, 1, v7
  v_lshl_add_u32 v7, s48, 2, v7
  v_and_b32 v8, 3, v1
  v_lshrrev_b32 v9, 1, v8
  v_add_u32 v7, v7, v9
  v_xor_b32 v7, v7, v6
  v_lshl_add_u32 v5, v7, 4, v5
  v_and_b32 v8, 1, v8
  v_lshl_add_u32 v85, v8, 3, v5
  v_add_u32 v97, 0x10000, v85
  s_lshl_b32 s32, s49, 7
  s_add_u32 s32, s32, 0x200000
  s_lshl_b32 s33, s50, 7
  v_mov_b32 v16, 0
  v_mov_b32 v17, 0
  v_mov_b32 v18, 0
  v_mov_b32 v19, 0
  v_mov_b32 v20, 0
  v_mov_b32 v21, 0
  v_mov_b32 v22, 0
  v_mov_b32 v23, 0
  v_mov_b32 v24, 0
  v_mov_b32 v25, 0
  v_mov_b32 v26, 0
  v_mov_b32 v27, 0
  v_mov_b32 v28, 0
  v_mov_b32 v29, 0
  v_mov_b32 v30, 0
  v_mov_b32 v31, 0
  s_add_u32 m0, s40, 0
  s_nop 0
  buffer_load_dwordx4 v72, s[16:19], s32 offen lds
  buffer_load_dwordx4 v73, s[16:19], s32 offen offset:1024 lds
  s_add_u32 s32, s32, 0x10000
  s_add_u32 m0, s40, 8192
  s_nop 0
  buffer_load_dwordx4 v74, s[8:11], s33 offen lds
  buffer_load_dwordx4 v75, s[8:11], s33 offen offset:1024 lds
  s_add_u32 s33, s33, 0x38000
  s_add_u32 m0, s40, 16384
  s_nop 0
  buffer_load_dwordx4 v72, s[16:19], s32 offen lds
  buffer_load_dwordx4 v73, s[16:19], s32 offen offset:1024 lds
  s_add_u32 s32, s32, 0x10000
  s_add_u32 m0, s40, 24576
  s_nop 0
  buffer_load_dwordx4 v74, s[8:11], s33 offen lds
  buffer_load_dwordx4 v75, s[8:11], s33 offen offset:1024 lds
  s_add_u32 s33, s33, 0x38000
  s_add_u32 m0, s40, 32768
  s_nop 0
  buffer_load_dwordx4 v72, s[16:19], s32 offen lds
  buffer_load_dwordx4 v73, s[16:19], s32 offen offset:1024 lds
  s_add_u32 s32, s32, 0x10000
  s_add_u32 m0, s40, 40960
  s_nop 0
  buffer_load_dwordx4 v74, s[8:11], s33 offen lds
  buffer_load_dwordx4 v75, s[8:11], s33 offen offset:1024 lds
  s_add_u32 s33, s33, 0x38000
  s_waitcnt vmcnt(8)
  s_barrier
  s_add_u32 m0, s40, 49152
  s_nop 0
  buffer_load_dwordx4 v72, s[16:19], s32 offen lds
  buffer_load_dwordx4 v73, s[16:19], s32 offen offset:1024 lds
  s_add_u32 s32, s32, 0x10000
  s_add_u32 m0, s40, 57344
  s_nop 0
  buffer_load_dwordx4 v74, s[8:11], s33 offen lds
  buffer_load_dwordx4 v75, s[8:11], s33 offen offset:1024 lds
  s_add_u32 s33, s33, 0x38000
  ds_read_b64_tr_b16 v[48:49], v84 offset:0
  ds_read_b64_tr_b16 v[50:51], v84 offset:512
  ds_read_b64_tr_b16 v[52:53], v85 offset:8192
  ds_read_b64_tr_b16 v[54:55], v85 offset:8704
  ds_read_b64_tr_b16 v[60:61], v84 offset:2048
  ds_read_b64_tr_b16 v[62:63], v84 offset:2560
  ds_read_b64_tr_b16 v[64:65], v85 offset:10240
  ds_read_b64_tr_b16 v[66:67], v85 offset:10752
  s_waitcnt lgkmcnt(4)
  v_mfma_f32_32x32x16_bf16 v[16:31], v[48:51], v[52:55], v[16:31]
  ds_read_b64_tr_b16 v[48:49], v84 offset:4096
  ds_read_b64_tr_b16 v[50:51], v84 offset:4608
  ds_read_b64_tr_b16 v[52:53], v85 offset:12288
  ds_read_b64_tr_b16 v[54:55], v85 offset:12800
  s_waitcnt lgkmcnt(4)
  v_mfma_f32_32x32x16_bf16 v[16:31], v[60:63], v[64:67], v[16:31]
  ds_read_b64_tr_b16 v[60:61], v84 offset:6144
  ds_read_b64_tr_b16 v[62:63], v84 offset:6656
  ds_read_b64_tr_b16 v[64:65], v85 offset:14336
  ds_read_b64_tr_b16 v[66:67], v85 offset:14848
  s_waitcnt lgkmcnt(4)
  v_mfma_f32_32x32x16_bf16 v[16:31], v[48:51], v[52:55], v[16:31]
  s_waitcnt lgkmcnt(0)
  v_mfma_f32_32x32x16_bf16 v[16:31], v[60:63], v[64:67], v[16:31]
  s_waitcnt vmcnt(8)
  s_barrier
  s_add_u32 m0, s40, 0
  s_nop 0
  buffer_load_dwordx4 v72, s[16:19], s32 offen lds
  buffer_load_dwordx4 v73, s[16:19], s32 offen offset:1024 lds
  s_add_u32 s32, s32, 0x10000
  s_add_u32 m0, s40, 8192
  s_nop 0
  buffer_load_dwordx4 v74, s[8:11], s33 offen lds
  buffer_load_dwordx4 v75, s[8:11], s33 offen offset:1024 lds
  s_add_u32 s33, s33, 0x38000
  ds_read_b64_tr_b16 v[48:49], v84 offset:16384
  ds_read_b64_tr_b16 v[50:51], v84 offset:16896
  ds_read_b64_tr_b16 v[52:53], v85 offset:24576
  ds_read_b64_tr_b16 v[54:55], v85 offset:25088
  ds_read_b64_tr_b16 v[60:61], v84 offset:18432
  ds_read_b64_tr_b16 v[62:63], v84 offset:18944
  ds_read_b64_tr_b16 v[64:65], v85 offset:26624
  ds_read_b64_tr_b16 v[66:67], v85 offset:27136
  s_waitcnt lgkmcnt(4)
  v_mfma_f32_32x32x16_bf16 v[16:31], v[48:51], v[52:55], v[16:31]
  ds_read_b64_tr_b16 v[48:49], v84 offset:20480
  ds_read_b64_tr_b16 v[50:51], v84 offset:20992
  ds_read_b64_tr_b16 v[52:53], v85 offset:28672
  ds_read_b64_tr_b16 v[54:55], v85 offset:29184
  s_waitcnt lgkmcnt(4)
  v_mfma_f32_32x32x16_bf16 v[16:31], v[60:63], v[64:67], v[16:31]
  ds_read_b64_tr_b16 v[60:61], v84 offset:22528
  ds_read_b64_tr_b16 v[62:63], v84 offset:23040
  ds_read_b64_tr_b16 v[64:65], v85 offset:30720
  ds_read_b64_tr_b16 v[66:67], v85 offset:31232
  s_waitcnt lgkmcnt(4)
  v_mfma_f32_32x32x16_bf16 v[16:31], v[48:51], v[52:55], v[16:31]
  s_waitcnt lgkmcnt(0)
  v_mfma_f32_32x32x16_bf16 v[16:31], v[60:63], v[64:67], v[16:31]
  s_waitcnt vmcnt(8)
  s_barrier
  s_add_u32 m0, s40, 16384
  s_nop 0
  buffer_load_dwordx4 v72, s[16:19], s32 offen lds
  buffer_load_dwordx4 v73, s[16:19], s32 offen offset:1024 lds
  s_add_u32 s32, s32, 0x10000
  s_add_u32 m0, s40, 24576
  s_nop 0
  buffer_load_dwordx4 v74, s[8:11], s33 offen lds
  buffer_load_dwordx4 v75, s[8:11], s33 offen offset:1024 lds
  s_add_u32 s33, s33, 0x38000
  ds_read_b64_tr_b16 v[48:49], v84 offset:32768
  ds_read_b64_tr_b16 v[50:51], v84 offset:33280
  ds_read_b64_tr_b16 v[52:53], v85 offset:40960
  ds_read_b64_tr_b16 v[54:55], v85 offset:41472
  ds_read_b64_tr_b16 v[60:61], v84 offset:34816
  ds_read_b64_tr_b16 v[62:63], v84 offset:35328
  ds_read_b64_tr_b16 v[64:65], v85 offset:43008
  ds_read_b64_tr_b16 v[66:67], v85 offset:43520
  s_waitcnt lgkmcnt(4)
  v_mfma_f32_32x32x16_bf16 v[16:31], v[48:51], v[52:55], v[16:31]
  ds_read_b64_tr_b16 v[48:49], v84 offset:36864
  ds_read_b64_tr_b16 v[50:51], v84 offset:37376
  ds_read_b64_tr_b16 v[52:53], v85 offset:45056
  ds_read_b64_tr_b16 v[54:55], v85 offset:45568
  s_waitcnt lgkmcnt(4)
  v_mfma_f32_32x32x16_bf16 v[16:31], v[60:63], v[64:67], v[16:31]
  ds_read_b64_tr_b16 v[60:61], v84 offset:38912
  ds_read_b64_tr_b16 v[62:63], v84 offset:39424
  ds_read_b64_tr_b16 v[64:65], v85 offset:47104
  ds_read_b64_tr_b16 v[66:67], v85 offset:47616
  s_waitcnt lgkmcnt(4)
  v_mfma_f32_32x32x16_bf16 v[16:31], v[48:51], v[52:55], v[16:31]
  s_waitcnt lgkmcnt(0)
  v_mfma_f32_32x32x16_bf16 v[16:31], v[60:63], v[64:67], v[16:31]
  s_waitcnt vmcnt(8)
  s_barrier
  s_add_u32 m0, s40, 32768
  s_nop 0
  buffer_load_dwordx4 v72, s[16:19], s32 offen lds
  buffer_load_dwordx4 v73, s[16:19], s32 offen offset:1024 lds
  s_add_u32 s32, s32, 0x10000
  s_add_u32 m0, s40, 40960
  s_nop 0
  buffer_load_dwordx4 v74, s[8:11], s33 offen lds
  buffer_load_dwordx4 v75, s[8:11], s33 offen offset:1024 lds
  s_add_u32 s33, s33, 0x38000
  ds_read_b64_tr_b16 v[48:49], v84 offset:49152
  ds_read_b64_tr_b16 v[50:51], v84 offset:49664
  ds_read_b64_tr_b16 v[52:53], v85 offset:57344
  ds_read_b64_tr_b16 v[54:55], v85 offset:57856
  ds_read_b64_tr_b16 v[60:61], v84 offset:51200
  ds_read_b64_tr_b16 v[62:63], v84 offset:51712
  ds_read_b64_tr_b16 v[64:65], v85 offset:59392
  ds_read_b64_tr_b16 v[66:67], v85 offset:59904
  s_waitcnt lgkmcnt(4)
  v_mfma_f32_32x32x16_bf16 v[16:31], v[48:51], v[52:55], v[16:31]
  ds_read_b64_tr_b16 v[48:49], v84 offset:53248
  ds_read_b64_tr_b16 v[50:51], v84 offset:53760
  ds_read_b64_tr_b16 v[52:53], v85 offset:61440
  ds_read_b64_tr_b16 v[54:55], v85 offset:61952
  s_waitcnt lgkmcnt(4)
  v_mfma_f32_32x32x16_bf16 v[16:31], v[60:63], v[64:67], v[16:31]
  ds_read_b64_tr_b16 v[60:61], v84 offset:55296
  ds_read_b64_tr_b16 v[62:63], v84 offset:55808
  ds_read_b64_tr_b16 v[64:65], v85 offset:63488
  ds_read_b64_tr_b16 v[66:67], v85 offset:64000
  s_waitcnt lgkmcnt(4)
  v_mfma_f32_32x32x16_bf16 v[16:31], v[48:51], v[52:55], v[16:31]
  s_waitcnt lgkmcnt(0)
  v_mfma_f32_32x32x16_bf16 v[16:31], v[60:63], v[64:67], v[16:31]
  s_waitcnt vmcnt(8)
  s_barrier
  s_add_u32 m0, s40, 49152
  s_nop 0
  buffer_load_dwordx4 v72, s[16:19], s32 offen lds
  buffer_load_dwordx4 v73, s[16:19], s32 offen offset:1024 lds
  s_add_u32 s32, s32, 0x10000
  s_add_u32 m0, s40, 57344
  s_nop 0
  buffer_load_dwordx4 v74, s[8:11], s33 offen lds
  buffer_load_dwordx4 v75, s[8:11], s33 offen offset:1024 lds
  s_add_u32 s33, s33, 0x38000
  ds_read_b64_tr_b16 v[48:49], v84 offset:0
  ds_read_b64_tr_b16 v[50:51], v84 offset:512
  ds_read_b64_tr_b16 v[52:53], v85 offset:8192
  ds_read_b64_tr_b16 v[54:55], v85 offset:8704
  ds_read_b64_tr_b16 v[60:61], v84 offset:2048
  ds_read_b64_tr_b16 v[62:63], v84 offset:2560
  ds_read_b64_tr_b16 v[64:65], v85 offset:10240
  ds_read_b64_tr_b16 v[66:67], v85 offset:10752
  s_waitcnt lgkmcnt(4)
  v_mfma_f32_32x32x16_bf16 v[16:31], v[48:51], v[52:55], v[16:31]
  ds_read_b64_tr_b16 v[48:49], v84 offset:4096
  ds_read_b64_tr_b16 v[50:51], v84 offset:4608
  ds_read_b64_tr_b16 v[52:53], v85 offset:12288
  ds_read_b64_tr_b16 v[54:55], v85 offset:12800
  s_waitcnt lgkmcnt(4)
  v_mfma_f32_32x32x16_bf16 v[16:31], v[60:63], v[64:67], v[16:31]
  ds_read_b64_tr_b16 v[60:61], v84 offset:6144
  ds_read_b64_tr_b16 v[62:63], v84 offset:6656
  ds_read_b64_tr_b16 v[64:65], v85 offset:14336
  ds_read_b64_tr_b16 v[66:67], v85 offset:14848
  s_waitcnt lgkmcnt(4)
  v_mfma_f32_32x32x16_bf16 v[16:31], v[48:51], v[52:55], v[16:31]
  s_waitcnt lgkmcnt(0)
  v_mfma_f32_32x32x16_bf16 v[16:31], v[60:63], v[64:67], v[16:31]
  s_waitcnt vmcnt(8)
  s_barrier
  s_add_u32 m0, s40, 0
  s_nop 0
  buffer_load_dwordx4 v72, s[16:19], s32 offen lds
  buffer_load_dwordx4 v73, s[16:19], s32 offen offset:1024 lds
  s_add_u32 s32, s32, 0x10000
  s_add_u32 m0, s40, 8192
  s_nop 0
  buffer_load_dwordx4 v74, s[8:11], s33 offen lds
  buffer_load_dwordx4 v75, s[8:11], s33 offen offset:1024 lds
  s_add_u32 s33, s33, 0x38000
  ds_read_b64_tr_b16 v[48:49], v84 offset:16384
  ds_read_b64_tr_b16 v[50:51], v84 offset:16896
  ds_read_b64_tr_b16 v[52:53], v85 offset:24576
  ds_read_b64_tr_b16 v[54:55], v85 offset:25088
  ds_read_b64_tr_b16 v[60:61], v84 offset:18432
  ds_read_b64_tr_b16 v[62:63], v84 offset:18944
  ds_read_b64_tr_b16 v[64:65], v85 offset:26624
  ds_read_b64_tr_b16 v[66:67], v85 offset:27136
  s_waitcnt lgkmcnt(4)
  v_mfma_f32_32x32x16_bf16 v[16:31], v[48:51], v[52:55], v[16:31]
  ds_read_b64_tr_b16 v[48:49], v84 offset:20480
  ds_read_b64_tr_b16 v[50:51], v84 offset:20992
  ds_read_b64_tr_b16 v[52:53], v85 offset:28672
  ds_read_b64_tr_b16 v[54:55], v85 offset:29184
  s_waitcnt lgkmcnt(4)
  v_mfma_f32_32x32x16_bf16 v[16:31], v[60:63], v[64:67], v[16:31]
  ds_read_b64_tr_b16 v[60:61], v84 offset:22528
  ds_read_b64_tr_b16 v[62:63], v84 offset:23040
  ds_read_b64_tr_b16 v[64:65], v85 offset:30720
  ds_read_b64_tr_b16 v[66:67], v85 offset:31232
  s_waitcnt lgkmcnt(4)
  v_mfma_f32_32x32x16_bf16 v[16:31], v[48:51], v[52:55], v[16:31]
  s_waitcnt lgkmcnt(0)
  v_mfma_f32_32x32x16_bf16 v[16:31], v[60:63], v[64:67], v[16:31]
  s_waitcnt vmcnt(8)
  s_barrier
  s_add_u32 m0, s40, 16384
  s_nop 0
  buffer_load_dwordx4 v72, s[16:19], s32 offen lds
  buffer_load_dwordx4 v73, s[16:19], s32 offen offset:1024 lds
  s_add_u32 s32, s32, 0x10000
  s_add_u32 m0, s40, 24576
  s_nop 0
  buffer_load_dwordx4 v74, s[8:11], s33 offen lds
  buffer_load_dwordx4 v75, s[8:11], s33 offen offset:1024 lds
  s_add_u32 s33, s33, 0x38000
  ds_read_b64_tr_b16 v[48:49], v84 offset:32768
  ds_read_b64_tr_b16 v[50:51], v84 offset:33280
  ds_read_b64_tr_b16 v[52:53], v85 offset:40960
  ds_read_b64_tr_b16 v[54:55], v85 offset:41472
  ds_read_b64_tr_b16 v[60:61], v84 offset:34816
  ds_read_b64_tr_b16 v[62:63], v84 offset:35328
  ds_read_b64_tr_b16 v[64:65], v85 offset:43008
  ds_read_b64_tr_b16 v[66:67], v85 offset:43520
  s_waitcnt lgkmcnt(4)
  v_mfma_f32_32x32x16_bf16 v[16:31], v[48:51], v[52:55], v[16:31]
  ds_read_b64_tr_b16 v[48:49], v84 offset:36864
  ds_read_b64_tr_b16 v[50:51], v84 offset:37376
  ds_read_b64_tr_b16 v[52:53], v85 offset:45056
  ds_read_b64_tr_b16 v[54:55], v85 offset:45568
  s_waitcnt lgkmcnt(4)
  v_mfma_f32_32x32x16_bf16 v[16:31], v[60:63], v[64:67], v[16:31]
  ds_read_b64_tr_b16 v[60:61], v84 offset:38912
  ds_read_b64_tr_b16 v[62:63], v84 offset:39424
  ds_read_b64_tr_b16 v[64:65], v85 offset:47104
  ds_read_b64_tr_b16 v[66:67], v85 offset:47616
  s_waitcnt lgkmcnt(4)
  v_mfma_f32_32x32x16_bf16 v[16:31], v[48:51], v[52:55], v[16:31]
  s_waitcnt lgkmcnt(0)
  v_mfma_f32_32x32x16_bf16 v[16:31], v[60:63], v[64:67], v[16:31]
  s_waitcnt vmcnt(8)
  s_barrier
  s_add_u32 m0, s40, 32768
  s_nop 0
  buffer_load_dwordx4 v72, s[16:19], s32 offen lds
  buffer_load_dwordx4 v73, s[16:19], s32 offen offset:1024 lds
  s_add_u32 s32, s32, 0x10000
  s_add_u32 m0, s40, 40960
  s_nop 0
  buffer_load_dwordx4 v74, s[8:11], s33 offen lds
  buffer_load_dwordx4 v75, s[8:11], s33 offen offset:1024 lds
  s_add_u32 s33, s33, 0x38000
  ds_read_b64_tr_b16 v[48:49], v84 offset:49152
  ds_read_b64_tr_b16 v[50:51], v84 offset:49664
  ds_read_b64_tr_b16 v[52:53], v85 offset:57344
  ds_read_b64_tr_b16 v[54:55], v85 offset:57856
  ds_read_b64_tr_b16 v[60:61], v84 offset:51200
  ds_read_b64_tr_b16 v[62:63], v84 offset:51712
  ds_read_b64_tr_b16 v[64:65], v85 offset:59392
  ds_read_b64_tr_b16 v[66:67], v85 offset:59904
  s_waitcnt lgkmcnt(4)
  v_mfma_f32_32x32x16_bf16 v[16:31], v[48:51], v[52:55], v[16:31]
  ds_read_b64_tr_b16 v[48:49], v84 offset:53248
  ds_read_b64_tr_b16 v[50:51], v84 offset:53760
  ds_read_b64_tr_b16 v[52:53], v85 offset:61440
  ds_read_b64_tr_b16 v[54:55], v85 offset:61952
  s_waitcnt lgkmcnt(4)
  v_mfma_f32_32x32x16_bf16 v[16:31], v[60:63], v[64:67], v[16:31]
  ds_read_b64_tr_b16 v[60:61], v84 offset:55296
  ds_read_b64_tr_b16 v[62:63], v84 offset:55808
  ds_read_b64_tr_b16 v[64:65], v85 offset:63488
  ds_read_b64_tr_b16 v[66:67], v85 offset:64000
  s_waitcnt lgkmcnt(4)
  v_mfma_f32_32x32x16_bf16 v[16:31], v[48:51], v[52:55], v[16:31]
  s_waitcnt lgkmcnt(0)
  v_mfma_f32_32x32x16_bf16 v[16:31], v[60:63], v[64:67], v[16:31]
  s_waitcnt vmcnt(8)
  s_barrier
  s_add_u32 m0, s40, 49152
  s_nop 0
  buffer_load_dwordx4 v72, s[16:19], s32 offen lds
  buffer_load_dwordx4 v73, s[16:19], s32 offen offset:1024 lds
  s_add_u32 s32, s32, 0x10000
  s_add_u32 m0, s40, 57344
  s_nop 0
  buffer_load_dwordx4 v74, s[8:11], s33 offen lds
  buffer_load_dwordx4 v75, s[8:11], s33 offen offset:1024 lds
  s_add_u32 s33, s33, 0x38000
  ds_read_b64_tr_b16 v[48:49], v84 offset:0
  ds_read_b64_tr_b16 v[50:51], v84 offset:512
  ds_read_b64_tr_b16 v[52:53], v85 offset:8192
  ds_read_b64_tr_b16 v[54:55], v85 offset:8704
  ds_read_b64_tr_b16 v[60:61], v84 offset:2048
  ds_read_b64_tr_b16 v[62:63], v84 offset:2560
  ds_read_b64_tr_b16 v[64:65], v85 offset:10240
  ds_read_b64_tr_b16 v[66:67], v85 offset:10752
  s_waitcnt lgkmcnt(4)
  v_mfma_f32_32x32x16_bf16 v[16:31], v[48:51], v[52:55], v[16:31]
  ds_read_b64_tr_b16 v[48:49], v84 offset:4096
  ds_read_b64_tr_b16 v[50:51], v84 offset:4608
  ds_read_b64_tr_b16 v[52:53], v85 offset:12288
  ds_read_b64_tr_b16 v[54:55], v85 offset:12800
  s_waitcnt lgkmcnt(4)
  v_mfma_f32_32x32x16_bf16 v[16:31], v[60:63], v[64:67], v[16:31]
  ds_read_b64_tr_b16 v[60:61], v84 offset:6144
  ds_read_b64_tr_b16 v[62:63], v84 offset:6656
  ds_read_b64_tr_b16 v[64:65], v85 offset:14336
  ds_read_b64_tr_b16 v[66:67], v85 offset:14848
  s_waitcnt lgkmcnt(4)
  v_mfma_f32_32x32x16_bf16 v[16:31], v[48:51], v[52:55], v[16:31]
  s_waitcnt lgkmcnt(0)
  v_mfma_f32_32x32x16_bf16 v[16:31], v[60:63], v[64:67], v[16:31]
  s_waitcnt vmcnt(8)
  s_barrier
  s_add_u32 m0, s40, 0
  s_nop 0
  buffer_load_dwordx4 v72, s[16:19], s32 offen lds
  buffer_load_dwordx4 v73, s[16:19], s32 offen offset:1024 lds
  s_add_u32 s32, s32, 0x10000
  s_add_u32 m0, s40, 8192
  s_nop 0
  buffer_load_dwordx4 v74, s[8:11], s33 offen lds
  buffer_load_dwordx4 v75, s[8:11], s33 offen offset:1024 lds
  s_add_u32 s33, s33, 0x38000
  ds_read_b64_tr_b16 v[48:49], v84 offset:16384
  ds_read_b64_tr_b16 v[50:51], v84 offset:16896
  ds_read_b64_tr_b16 v[52:53], v85 offset:24576
  ds_read_b64_tr_b16 v[54:55], v85 offset:25088
  ds_read_b64_tr_b16 v[60:61], v84 offset:18432
  ds_read_b64_tr_b16 v[62:63], v84 offset:18944
  ds_read_b64_tr_b16 v[64:65], v85 offset:26624
  ds_read_b64_tr_b16 v[66:67], v85 offset:27136
  s_waitcnt lgkmcnt(4)
  v_mfma_f32_32x32x16_bf16 v[16:31], v[48:51], v[52:55], v[16:31]
  ds_read_b64_tr_b16 v[48:49], v84 offset:20480
  ds_read_b64_tr_b16 v[50:51], v84 offset:20992
  ds_read_b64_tr_b16 v[52:53], v85 offset:28672
  ds_read_b64_tr_b16 v[54:55], v85 offset:29184
  s_waitcnt lgkmcnt(4)
  v_mfma_f32_32x32x16_bf16 v[16:31], v[60:63], v[64:67], v[16:31]
  ds_read_b64_tr_b16 v[60:61], v84 offset:22528
  ds_read_b64_tr_b16 v[62:63], v84 offset:23040
  ds_read_b64_tr_b16 v[64:65], v85 offset:30720
  ds_read_b64_tr_b16 v[66:67], v85 offset:31232
  s_waitcnt lgkmcnt(4)
  v_mfma_f32_32x32x16_bf16 v[16:31], v[48:51], v[52:55], v[16:31]
  s_waitcnt lgkmcnt(0)
  v_mfma_f32_32x32x16_bf16 v[16:31], v[60:63], v[64:67], v[16:31]
  s_waitcnt vmcnt(8)
  s_barrier
  s_add_u32 m0, s40, 16384
  s_nop 0
  buffer_load_dwordx4 v72, s[16:19], s32 offen lds
  buffer_load_dwordx4 v73, s[16:19], s32 offen offset:1024 lds
  s_add_u32 s32, s32, 0x10000
  s_add_u32 m0, s40, 24576
  s_nop 0
  buffer_load_dwordx4 v74, s[8:11], s33 offen lds
  buffer_load_dwordx4 v75, s[8:11], s33 offen offset:1024 lds
  s_add_u32 s33, s33, 0x38000
  ds_read_b64_tr_b16 v[48:49], v84 offset:32768
  ds_read_b64_tr_b16 v[50:51], v84 offset:33280
  ds_read_b64_tr_b16 v[52:53], v85 offset:40960
  ds_read_b64_tr_b16 v[54:55], v85 offset:41472
  ds_read_b64_tr_b16 v[60:61], v84 offset:34816
  ds_read_b64_tr_b16 v[62:63], v84 offset:35328
  ds_read_b64_tr_b16 v[64:65], v85 offset:43008
  ds_read_b64_tr_b16 v[66:67], v85 offset:43520
  s_waitcnt lgkmcnt(4)
  v_mfma_f32_32x32x16_bf16 v[16:31], v[48:51], v[52:55], v[16:31]
  ds_read_b64_tr_b16 v[48:49], v84 offset:36864
  ds_read_b64_tr_b16 v[50:51], v84 offset:37376
  ds_read_b64_tr_b16 v[52:53], v85 offset:45056
  ds_read_b64_tr_b16 v[54:55], v85 offset:45568
  s_waitcnt lgkmcnt(4)
  v_mfma_f32_32x32x16_bf16 v[16:31], v[60:63], v[64:67], v[16:31]
  ds_read_b64_tr_b16 v[60:61], v84 offset:38912
  ds_read_b64_tr_b16 v[62:63], v84 offset:39424
  ds_read_b64_tr_b16 v[64:65], v85 offset:47104
  ds_read_b64_tr_b16 v[66:67], v85 offset:47616
  s_waitcnt lgkmcnt(4)
  v_mfma_f32_32x32x16_bf16 v[16:31], v[48:51], v[52:55], v[16:31]
  s_waitcnt lgkmcnt(0)
  v_mfma_f32_32x32x16_bf16 v[16:31], v[60:63], v[64:67], v[16:31]
  s_waitcnt vmcnt(8)
  s_barrier
  s_add_u32 m0, s40, 32768
  s_nop 0
  buffer_load_dwordx4 v72, s[16:19], s32 offen lds
  buffer_load_dwordx4 v73, s[16:19], s32 offen offset:1024 lds
  s_add_u32 s32, s32, 0x10000
  s_add_u32 m0, s40, 40960
  s_nop 0
  buffer_load_dwordx4 v74, s[8:11], s33 offen lds
  buffer_load_dwordx4 v75, s[8:11], s33 offen offset:1024 lds
  s_add_u32 s33, s33, 0x38000
  ds_read_b64_tr_b16 v[48:49], v84 offset:49152
  ds_read_b64_tr_b16 v[50:51], v84 offset:49664
  ds_read_b64_tr_b16 v[52:53], v85 offset:57344
  ds_read_b64_tr_b16 v[54:55], v85 offset:57856
  ds_read_b64_tr_b16 v[60:61], v84 offset:51200
  ds_read_b64_tr_b16 v[62:63], v84 offset:51712
  ds_read_b64_tr_b16 v[64:65], v85 offset:59392
  ds_read_b64_tr_b16 v[66:67], v85 offset:59904
  s_waitcnt lgkmcnt(4)
  v_mfma_f32_32x32x16_bf16 v[16:31], v[48:51], v[52:55], v[16:31]
  ds_read_b64_tr_b16 v[48:49], v84 offset:53248
  ds_read_b64_tr_b16 v[50:51], v84 offset:53760
  ds_read_b64_tr_b16 v[52:53], v85 offset:61440
  ds_read_b64_tr_b16 v[54:55], v85 offset:61952
  s_waitcnt lgkmcnt(4)
  v_mfma_f32_32x32x16_bf16 v[16:31], v[60:63], v[64:67], v[16:31]
  ds_read_b64_tr_b16 v[60:61], v84 offset:55296
  ds_read_b64_tr_b16 v[62:63], v84 offset:55808
  ds_read_b64_tr_b16 v[64:65], v85 offset:63488
  ds_read_b64_tr_b16 v[66:67], v85 offset:64000
  s_waitcnt lgkmcnt(4)
  v_mfma_f32_32x32x16_bf16 v[16:31], v[48:51], v[52:55], v[16:31]
  s_waitcnt lgkmcnt(0)
  v_mfma_f32_32x32x16_bf16 v[16:31], v[60:63], v[64:67], v[16:31]
  s_waitcnt vmcnt(8)
  s_barrier
  s_add_u32 m0, s40, 49152
  s_nop 0
  buffer_load_dwordx4 v72, s[16:19], s32 offen lds
  buffer_load_dwordx4 v73, s[16:19], s32 offen offset:1024 lds
  s_add_u32 s32, s32, 0x10000
  s_add_u32 m0, s40, 57344
  s_nop 0
  buffer_load_dwordx4 v74, s[8:11], s33 offen lds
  buffer_load_dwordx4 v75, s[8:11], s33 offen offset:1024 lds
  s_add_u32 s33, s33, 0x38000
  ds_read_b64_tr_b16 v[48:49], v84 offset:0
  ds_read_b64_tr_b16 v[50:51], v84 offset:512
  ds_read_b64_tr_b16 v[52:53], v85 offset:8192
  ds_read_b64_tr_b16 v[54:55], v85 offset:8704
  ds_read_b64_tr_b16 v[60:61], v84 offset:2048
  ds_read_b64_tr_b16 v[62:63], v84 offset:2560
  ds_read_b64_tr_b16 v[64:65], v85 offset:10240
  ds_read_b64_tr_b16 v[66:67], v85 offset:10752
  s_waitcnt lgkmcnt(4)
  v_mfma_f32_32x32x16_bf16 v[16:31], v[48:51], v[52:55], v[16:31]
  ds_read_b64_tr_b16 v[48:49], v84 offset:4096
  ds_read_b64_tr_b16 v[50:51], v84 offset:4608
  ds_read_b64_tr_b16 v[52:53], v85 offset:12288
  ds_read_b64_tr_b16 v[54:55], v85 offset:12800
  s_waitcnt lgkmcnt(4)
  v_mfma_f32_32x32x16_bf16 v[16:31], v[60:63], v[64:67], v[16:31]
  ds_read_b64_tr_b16 v[60:61], v84 offset:6144
  ds_read_b64_tr_b16 v[62:63], v84 offset:6656
  ds_read_b64_tr_b16 v[64:65], v85 offset:14336
  ds_read_b64_tr_b16 v[66:67], v85 offset:14848
  s_waitcnt lgkmcnt(4)
  v_mfma_f32_32x32x16_bf16 v[16:31], v[48:51], v[52:55], v[16:31]
  s_waitcnt lgkmcnt(0)
  v_mfma_f32_32x32x16_bf16 v[16:31], v[60:63], v[64:67], v[16:31]
  s_waitcnt vmcnt(8)
  s_barrier
  s_add_u32 m0, s40, 0
  s_nop 0
  buffer_load_dwordx4 v72, s[16:19], s32 offen lds
  buffer_load_dwordx4 v73, s[16:19], s32 offen offset:1024 lds
  s_add_u32 s32, s32, 0x10000
  s_add_u32 m0, s40, 8192
  s_nop 0
  buffer_load_dwordx4 v74, s[8:11], s33 offen lds
  buffer_load_dwordx4 v75, s[8:11], s33 offen offset:1024 lds
  s_add_u32 s33, s33, 0x38000
  ds_read_b64_tr_b16 v[48:49], v84 offset:16384
  ds_read_b64_tr_b16 v[50:51], v84 offset:16896
  ds_read_b64_tr_b16 v[52:53], v85 offset:24576
  ds_read_b64_tr_b16 v[54:55], v85 offset:25088
  ds_read_b64_tr_b16 v[60:61], v84 offset:18432
  ds_read_b64_tr_b16 v[62:63], v84 offset:18944
  ds_read_b64_tr_b16 v[64:65], v85 offset:26624
  ds_read_b64_tr_b16 v[66:67], v85 offset:27136
  s_waitcnt lgkmcnt(4)
  v_mfma_f32_32x32x16_bf16 v[16:31], v[48:51], v[52:55], v[16:31]
  ds_read_b64_tr_b16 v[48:49], v84 offset:20480
  ds_read_b64_tr_b16 v[50:51], v84 offset:20992
  ds_read_b64_tr_b16 v[52:53], v85 offset:28672
  ds_read_b64_tr_b16 v[54:55], v85 offset:29184
  s_waitcnt lgkmcnt(4)
  v_mfma_f32_32x32x16_bf16 v[16:31], v[60:63], v[64:67], v[16:31]
  ds_read_b64_tr_b16 v[60:61], v84 offset:22528
  ds_read_b64_tr_b16 v[62:63], v84 offset:23040
  ds_read_b64_tr_b16 v[64:65], v85 offset:30720
  ds_read_b64_tr_b16 v[66:67], v85 offset:31232
  s_waitcnt lgkmcnt(4)
  v_mfma_f32_32x32x16_bf16 v[16:31], v[48:51], v[52:55], v[16:31]
  s_waitcnt lgkmcnt(0)
  v_mfma_f32_32x32x16_bf16 v[16:31], v[60:63], v[64:67], v[16:31]
  s_waitcnt vmcnt(8)
  s_barrier
  s_add_u32 m0, s40, 16384
  s_nop 0
  buffer_load_dwordx4 v72, s[16:19], s32 offen lds
  buffer_load_dwordx4 v73, s[16:19], s32 offen offset:1024 lds
  s_add_u32 s32, s32, 0x10000
  s_add_u32 m0, s40, 24576
  s_nop 0
  buffer_load_dwordx4 v74, s[8:11], s33 offen lds
  buffer_load_dwordx4 v75, s[8:11], s33 offen offset:1024 lds
  s_add_u32 s33, s33, 0x38000
  ds_read_b64_tr_b16 v[48:49], v84 offset:32768
  ds_read_b64_tr_b16 v[50:51], v84 offset:33280
  ds_read_b64_tr_b16 v[52:53], v85 offset:40960
  ds_read_b64_tr_b16 v[54:55], v85 offset:41472
  ds_read_b64_tr_b16 v[60:61], v84 offset:34816
  ds_read_b64_tr_b16 v[62:63], v84 offset:35328
  ds_read_b64_tr_b16 v[64:65], v85 offset:43008
  ds_read_b64_tr_b16 v[66:67], v85 offset:43520
  s_waitcnt lgkmcnt(4)
  v_mfma_f32_32x32x16_bf16 v[16:31], v[48:51], v[52:55], v[16:31]
  ds_read_b64_tr_b16 v[48:49], v84 offset:36864
  ds_read_b64_tr_b16 v[50:51], v84 offset:37376
  ds_read_b64_tr_b16 v[52:53], v85 offset:45056
  ds_read_b64_tr_b16 v[54:55], v85 offset:45568
  s_waitcnt lgkmcnt(4)
  v_mfma_f32_32x32x16_bf16 v[16:31], v[60:63], v[64:67], v[16:31]
  ds_read_b64_tr_b16 v[60:61], v84 offset:38912
  ds_read_b64_tr_b16 v[62:63], v84 offset:39424
  ds_read_b64_tr_b16 v[64:65], v85 offset:47104
  ds_read_b64_tr_b16 v[66:67], v85 offset:47616
  s_waitcnt lgkmcnt(4)
  v_mfma_f32_32x32x16_bf16 v[16:31], v[48:51], v[52:55], v[16:31]
  s_waitcnt lgkmcnt(0)
  v_mfma_f32_32x32x16_bf16 v[16:31], v[60:63], v[64:67], v[16:31]
  s_waitcnt vmcnt(8)
  s_barrier
  s_add_u32 m0, s40, 32768
  s_nop 0
  buffer_load_dwordx4 v72, s[16:19], s32 offen lds
  buffer_load_dwordx4 v73, s[16:19], s32 offen offset:1024 lds
  s_add_u32 s32, s32, 0x10000
  s_add_u32 m0, s40, 40960
  s_nop 0
  buffer_load_dwordx4 v74, s[8:11], s33 offen lds
  buffer_load_dwordx4 v75, s[8:11], s33 offen offset:1024 lds
  s_add_u32 s33, s33, 0x38000
  ds_read_b64_tr_b16 v[48:49], v84 offset:49152
  ds_read_b64_tr_b16 v[50:51], v84 offset:49664
  ds_read_b64_tr_b16 v[52:53], v85 offset:57344
  ds_read_b64_tr_b16 v[54:55], v85 offset:57856
  ds_read_b64_tr_b16 v[60:61], v84 offset:51200
  ds_read_b64_tr_b16 v[62:63], v84 offset:51712
  ds_read_b64_tr_b16 v[64:65], v85 offset:59392
  ds_read_b64_tr_b16 v[66:67], v85 offset:59904
  s_waitcnt lgkmcnt(4)
  v_mfma_f32_32x32x16_bf16 v[16:31], v[48:51], v[52:55], v[16:31]
  ds_read_b64_tr_b16 v[48:49], v84 offset:53248
  ds_read_b64_tr_b16 v[50:51], v84 offset:53760
  ds_read_b64_tr_b16 v[52:53], v85 offset:61440
  ds_read_b64_tr_b16 v[54:55], v85 offset:61952
  s_waitcnt lgkmcnt(4)
  v_mfma_f32_32x32x16_bf16 v[16:31], v[60:63], v[64:67], v[16:31]
  ds_read_b64_tr_b16 v[60:61], v84 offset:55296
  ds_read_b64_tr_b16 v[62:63], v84 offset:55808
  ds_read_b64_tr_b16 v[64:65], v85 offset:63488
  ds_read_b64_tr_b16 v[66:67], v85 offset:64000
  s_waitcnt lgkmcnt(4)
  v_mfma_f32_32x32x16_bf16 v[16:31], v[48:51], v[52:55], v[16:31]
  s_waitcnt lgkmcnt(0)
  v_mfma_f32_32x32x16_bf16 v[16:31], v[60:63], v[64:67], v[16:31]
  s_waitcnt vmcnt(8)
  s_barrier
  s_add_u32 m0, s40, 49152
  s_nop 0
  buffer_load_dwordx4 v72, s[16:19], s32 offen lds
  buffer_load_dwordx4 v73, s[16:19], s32 offen offset:1024 lds
  s_add_u32 s32, s32, 0x10000
  s_add_u32 m0, s40, 57344
  s_nop 0
  buffer_load_dwordx4 v74, s[8:11], s33 offen lds
  buffer_load_dwordx4 v75, s[8:11], s33 offen offset:1024 lds
  s_add_u32 s33, s33, 0x38000
  ds_read_b64_tr_b16 v[48:49], v84 offset:0
  ds_read_b64_tr_b16 v[50:51], v84 offset:512
  ds_read_b64_tr_b16 v[52:53], v85 offset:8192
  ds_read_b64_tr_b16 v[54:55], v85 offset:8704
  ds_read_b64_tr_b16 v[60:61], v84 offset:2048
  ds_read_b64_tr_b16 v[62:63], v84 offset:2560
  ds_read_b64_tr_b16 v[64:65], v85 offset:10240
  ds_read_b64_tr_b16 v[66:67], v85 offset:10752
  s_waitcnt lgkmcnt(4)
  v_mfma_f32_32x32x16_bf16 v[16:31], v[48:51], v[52:55], v[16:31]
  ds_read_b64_tr_b16 v[48:49], v84 offset:4096
  ds_read_b64_tr_b16 v[50:51], v84 offset:4608
  ds_read_b64_tr_b16 v[52:53], v85 offset:12288
  ds_read_b64_tr_b16 v[54:55], v85 offset:12800
  s_waitcnt lgkmcnt(4)
  v_mfma_f32_32x32x16_bf16 v[16:31], v[60:63], v[64:67], v[16:31]
  ds_read_b64_tr_b16 v[60:61], v84 offset:6144
  ds_read_b64_tr_b16 v[62:63], v84 offset:6656
  ds_read_b64_tr_b16 v[64:65], v85 offset:14336
  ds_read_b64_tr_b16 v[66:67], v85 offset:14848
  s_waitcnt lgkmcnt(4)
  v_mfma_f32_32x32x16_bf16 v[16:31], v[48:51], v[52:55], v[16:31]
  s_waitcnt lgkmcnt(0)
  v_mfma_f32_32x32x16_bf16 v[16:31], v[60:63], v[64:67], v[16:31]
  s_waitcnt vmcnt(8)
  s_barrier
  s_add_u32 m0, s40, 0
  s_nop 0
  buffer_load_dwordx4 v72, s[16:19], s32 offen lds
  buffer_load_dwordx4 v73, s[16:19], s32 offen offset:1024 lds
  s_add_u32 s32, s32, 0x10000
  s_add_u32 m0, s40, 8192
  s_nop 0
  buffer_load_dwordx4 v74, s[8:11], s33 offen lds
  buffer_load_dwordx4 v75, s[8:11], s33 offen offset:1024 lds
  s_add_u32 s33, s33, 0x38000
  ds_read_b64_tr_b16 v[48:49], v84 offset:16384
  ds_read_b64_tr_b16 v[50:51], v84 offset:16896
  ds_read_b64_tr_b16 v[52:53], v85 offset:24576
  ds_read_b64_tr_b16 v[54:55], v85 offset:25088
  ds_read_b64_tr_b16 v[60:61], v84 offset:18432
  ds_read_b64_tr_b16 v[62:63], v84 offset:18944
  ds_read_b64_tr_b16 v[64:65], v85 offset:26624
  ds_read_b64_tr_b16 v[66:67], v85 offset:27136
  s_waitcnt lgkmcnt(4)
  v_mfma_f32_32x32x16_bf16 v[16:31], v[48:51], v[52:55], v[16:31]
  ds_read_b64_tr_b16 v[48:49], v84 offset:20480
  ds_read_b64_tr_b16 v[50:51], v84 offset:20992
  ds_read_b64_tr_b16 v[52:53], v85 offset:28672
  ds_read_b64_tr_b16 v[54:55], v85 offset:29184
  s_waitcnt lgkmcnt(4)
  v_mfma_f32_32x32x16_bf16 v[16:31], v[60:63], v[64:67], v[16:31]
  ds_read_b64_tr_b16 v[60:61], v84 offset:22528
  ds_read_b64_tr_b16 v[62:63], v84 offset:23040
  ds_read_b64_tr_b16 v[64:65], v85 offset:30720
  ds_read_b64_tr_b16 v[66:67], v85 offset:31232
  s_waitcnt lgkmcnt(4)
  v_mfma_f32_32x32x16_bf16 v[16:31], v[48:51], v[52:55], v[16:31]
  s_waitcnt lgkmcnt(0)
  v_mfma_f32_32x32x16_bf16 v[16:31], v[60:63], v[64:67], v[16:31]
  s_waitcnt vmcnt(8)
  s_barrier
  s_add_u32 m0, s40, 16384
  s_nop 0
  buffer_load_dwordx4 v72, s[16:19], s32 offen lds
  buffer_load_dwordx4 v73, s[16:19], s32 offen offset:1024 lds
  s_add_u32 s32, s32, 0x10000
  s_add_u32 m0, s40, 24576
  s_nop 0
  buffer_load_dwordx4 v74, s[8:11], s33 offen lds
  buffer_load_dwordx4 v75, s[8:11], s33 offen offset:1024 lds
  s_add_u32 s33, s33, 0x38000
  ds_read_b64_tr_b16 v[48:49], v84 offset:32768
  ds_read_b64_tr_b16 v[50:51], v84 offset:33280
  ds_read_b64_tr_b16 v[52:53], v85 offset:40960
  ds_read_b64_tr_b16 v[54:55], v85 offset:41472
  ds_read_b64_tr_b16 v[60:61], v84 offset:34816
  ds_read_b64_tr_b16 v[62:63], v84 offset:35328
  ds_read_b64_tr_b16 v[64:65], v85 offset:43008
  ds_read_b64_tr_b16 v[66:67], v85 offset:43520
  s_waitcnt lgkmcnt(4)
  v_mfma_f32_32x32x16_bf16 v[16:31], v[48:51], v[52:55], v[16:31]
  ds_read_b64_tr_b16 v[48:49], v84 offset:36864
  ds_read_b64_tr_b16 v[50:51], v84 offset:37376
  ds_read_b64_tr_b16 v[52:53], v85 offset:45056
  ds_read_b64_tr_b16 v[54:55], v85 offset:45568
  s_waitcnt lgkmcnt(4)
  v_mfma_f32_32x32x16_bf16 v[16:31], v[60:63], v[64:67], v[16:31]
  ds_read_b64_tr_b16 v[60:61], v84 offset:38912
  ds_read_b64_tr_b16 v[62:63], v84 offset:39424
  ds_read_b64_tr_b16 v[64:65], v85 offset:47104
  ds_read_b64_tr_b16 v[66:67], v85 offset:47616
  s_waitcnt lgkmcnt(4)
  v_mfma_f32_32x32x16_bf16 v[16:31], v[48:51], v[52:55], v[16:31]
  s_waitcnt lgkmcnt(0)
  v_mfma_f32_32x32x16_bf16 v[16:31], v[60:63], v[64:67], v[16:31]
  s_waitcnt vmcnt(8)
  s_barrier
  s_add_u32 m0, s40, 32768
  s_nop 0
  buffer_load_dwordx4 v72, s[16:19], s32 offen lds
  buffer_load_dwordx4 v73, s[16:19], s32 offen offset:1024 lds
  s_add_u32 s32, s32, 0x10000
  s_add_u32 m0, s40, 40960
  s_nop 0
  buffer_load_dwordx4 v74, s[8:11], s33 offen lds
  buffer_load_dwordx4 v75, s[8:11], s33 offen offset:1024 lds
  s_add_u32 s33, s33, 0x38000
  ds_read_b64_tr_b16 v[48:49], v84 offset:49152
  ds_read_b64_tr_b16 v[50:51], v84 offset:49664
  ds_read_b64_tr_b16 v[52:53], v85 offset:57344
  ds_read_b64_tr_b16 v[54:55], v85 offset:57856
  ds_read_b64_tr_b16 v[60:61], v84 offset:51200
  ds_read_b64_tr_b16 v[62:63], v84 offset:51712
  ds_read_b64_tr_b16 v[64:65], v85 offset:59392
  ds_read_b64_tr_b16 v[66:67], v85 offset:59904
  s_waitcnt lgkmcnt(4)
  v_mfma_f32_32x32x16_bf16 v[16:31], v[48:51], v[52:55], v[16:31]
  ds_read_b64_tr_b16 v[48:49], v84 offset:53248
  ds_read_b64_tr_b16 v[50:51], v84 offset:53760
  ds_read_b64_tr_b16 v[52:53], v85 offset:61440
  ds_read_b64_tr_b16 v[54:55], v85 offset:61952
  s_waitcnt lgkmcnt(4)
  v_mfma_f32_32x32x16_bf16 v[16:31], v[60:63], v[64:67], v[16:31]
  ds_read_b64_tr_b16 v[60:61], v84 offset:55296
  ds_read_b64_tr_b16 v[62:63], v84 offset:55808
  ds_read_b64_tr_b16 v[64:65], v85 offset:63488
  ds_read_b64_tr_b16 v[66:67], v85 offset:64000
  s_waitcnt lgkmcnt(4)
  v_mfma_f32_32x32x16_bf16 v[16:31], v[48:51], v[52:55], v[16:31]
  s_waitcnt lgkmcnt(0)
  v_mfma_f32_32x32x16_bf16 v[16:31], v[60:63], v[64:67], v[16:31]
  s_waitcnt vmcnt(8)
  s_barrier
  s_add_u32 m0, s40, 49152
  s_nop 0
  buffer_load_dwordx4 v72, s[16:19], s32 offen lds
  buffer_load_dwordx4 v73, s[16:19], s32 offen offset:1024 lds
  s_add_u32 s32, s32, 0x10000
  s_add_u32 m0, s40, 57344
  s_nop 0
  buffer_load_dwordx4 v74, s[8:11], s33 offen lds
  buffer_load_dwordx4 v75, s[8:11], s33 offen offset:1024 lds
  s_add_u32 s33, s33, 0x38000
  ds_read_b64_tr_b16 v[48:49], v84 offset:0
  ds_read_b64_tr_b16 v[50:51], v84 offset:512
  ds_read_b64_tr_b16 v[52:53], v85 offset:8192
  ds_read_b64_tr_b16 v[54:55], v85 offset:8704
  ds_read_b64_tr_b16 v[60:61], v84 offset:2048
  ds_read_b64_tr_b16 v[62:63], v84 offset:2560
  ds_read_b64_tr_b16 v[64:65], v85 offset:10240
  ds_read_b64_tr_b16 v[66:67], v85 offset:10752
  s_waitcnt lgkmcnt(4)
  v_mfma_f32_32x32x16_bf16 v[16:31], v[48:51], v[52:55], v[16:31]
  ds_read_b64_tr_b16 v[48:49], v84 offset:4096
  ds_read_b64_tr_b16 v[50:51], v84 offset:4608
  ds_read_b64_tr_b16 v[52:53], v85 offset:12288
  ds_read_b64_tr_b16 v[54:55], v85 offset:12800
  s_waitcnt lgkmcnt(4)
  v_mfma_f32_32x32x16_bf16 v[16:31], v[60:63], v[64:67], v[16:31]
  ds_read_b64_tr_b16 v[60:61], v84 offset:6144
  ds_read_b64_tr_b16 v[62:63], v84 offset:6656
  ds_read_b64_tr_b16 v[64:65], v85 offset:14336
  ds_read_b64_tr_b16 v[66:67], v85 offset:14848
  s_waitcnt lgkmcnt(4)
  v_mfma_f32_32x32x16_bf16 v[16:31], v[48:51], v[52:55], v[16:31]
  s_waitcnt lgkmcnt(0)
  v_mfma_f32_32x32x16_bf16 v[16:31], v[60:63], v[64:67], v[16:31]
  s_waitcnt vmcnt(8)
  s_barrier
  s_add_u32 m0, s40, 0
  s_nop 0
  buffer_load_dwordx4 v72, s[16:19], s32 offen lds
  buffer_load_dwordx4 v73, s[16:19], s32 offen offset:1024 lds
  s_add_u32 s32, s32, 0x10000
  s_add_u32 m0, s40, 8192
  s_nop 0
  buffer_load_dwordx4 v74, s[8:11], s33 offen lds
  buffer_load_dwordx4 v75, s[8:11], s33 offen offset:1024 lds
  s_add_u32 s33, s33, 0x38000
  ds_read_b64_tr_b16 v[48:49], v84 offset:16384
  ds_read_b64_tr_b16 v[50:51], v84 offset:16896
  ds_read_b64_tr_b16 v[52:53], v85 offset:24576
  ds_read_b64_tr_b16 v[54:55], v85 offset:25088
  ds_read_b64_tr_b16 v[60:61], v84 offset:18432
  ds_read_b64_tr_b16 v[62:63], v84 offset:18944
  ds_read_b64_tr_b16 v[64:65], v85 offset:26624
  ds_read_b64_tr_b16 v[66:67], v85 offset:27136
  s_waitcnt lgkmcnt(4)
  v_mfma_f32_32x32x16_bf16 v[16:31], v[48:51], v[52:55], v[16:31]
  ds_read_b64_tr_b16 v[48:49], v84 offset:20480
  ds_read_b64_tr_b16 v[50:51], v84 offset:20992
  ds_read_b64_tr_b16 v[52:53], v85 offset:28672
  ds_read_b64_tr_b16 v[54:55], v85 offset:29184
  s_waitcnt lgkmcnt(4)
  v_mfma_f32_32x32x16_bf16 v[16:31], v[60:63], v[64:67], v[16:31]
  ds_read_b64_tr_b16 v[60:61], v84 offset:22528
  ds_read_b64_tr_b16 v[62:63], v84 offset:23040
  ds_read_b64_tr_b16 v[64:65], v85 offset:30720
  ds_read_b64_tr_b16 v[66:67], v85 offset:31232
  s_waitcnt lgkmcnt(4)
  v_mfma_f32_32x32x16_bf16 v[16:31], v[48:51], v[52:55], v[16:31]
  s_waitcnt lgkmcnt(0)
  v_mfma_f32_32x32x16_bf16 v[16:31], v[60:63], v[64:67], v[16:31]
  s_waitcnt vmcnt(8)
  s_barrier
  s_add_u32 m0, s40, 16384
  s_nop 0
  buffer_load_dwordx4 v72, s[16:19], s32 offen lds
  buffer_load_dwordx4 v73, s[16:19], s32 offen offset:1024 lds
  s_add_u32 s32, s32, 0x10000
  s_add_u32 m0, s40, 24576
  s_nop 0
  buffer_load_dwordx4 v74, s[8:11], s33 offen lds
  buffer_load_dwordx4 v75, s[8:11], s33 offen offset:1024 lds
  s_add_u32 s33, s33, 0x38000
  ds_read_b64_tr_b16 v[48:49], v84 offset:32768
  ds_read_b64_tr_b16 v[50:51], v84 offset:33280
  ds_read_b64_tr_b16 v[52:53], v85 offset:40960
  ds_read_b64_tr_b16 v[54:55], v85 offset:41472
  ds_read_b64_tr_b16 v[60:61], v84 offset:34816
  ds_read_b64_tr_b16 v[62:63], v84 offset:35328
  ds_read_b64_tr_b16 v[64:65], v85 offset:43008
  ds_read_b64_tr_b16 v[66:67], v85 offset:43520
  s_waitcnt lgkmcnt(4)
  v_mfma_f32_32x32x16_bf16 v[16:31], v[48:51], v[52:55], v[16:31]
  ds_read_b64_tr_b16 v[48:49], v84 offset:36864
  ds_read_b64_tr_b16 v[50:51], v84 offset:37376
  ds_read_b64_tr_b16 v[52:53], v85 offset:45056
  ds_read_b64_tr_b16 v[54:55], v85 offset:45568
  s_waitcnt lgkmcnt(4)
  v_mfma_f32_32x32x16_bf16 v[16:31], v[60:63], v[64:67], v[16:31]
  ds_read_b64_tr_b16 v[60:61], v84 offset:38912
  ds_read_b64_tr_b16 v[62:63], v84 offset:39424
  ds_read_b64_tr_b16 v[64:65], v85 offset:47104
  ds_read_b64_tr_b16 v[66:67], v85 offset:47616
  s_waitcnt lgkmcnt(4)
  v_mfma_f32_32x32x16_bf16 v[16:31], v[48:51], v[52:55], v[16:31]
  s_waitcnt lgkmcnt(0)
  v_mfma_f32_32x32x16_bf16 v[16:31], v[60:63], v[64:67], v[16:31]
  s_waitcnt vmcnt(8)
  s_barrier
  s_add_u32 m0, s40, 32768
  s_nop 0
  buffer_load_dwordx4 v72, s[16:19], s32 offen lds
  buffer_load_dwordx4 v73, s[16:19], s32 offen offset:1024 lds
  s_add_u32 s32, s32, 0x10000
  s_add_u32 m0, s40, 40960
  s_nop 0
  buffer_load_dwordx4 v74, s[8:11], s33 offen lds
  buffer_load_dwordx4 v75, s[8:11], s33 offen offset:1024 lds
  s_add_u32 s33, s33, 0x38000
  ds_read_b64_tr_b16 v[48:49], v84 offset:49152
  ds_read_b64_tr_b16 v[50:51], v84 offset:49664
  ds_read_b64_tr_b16 v[52:53], v85 offset:57344
  ds_read_b64_tr_b16 v[54:55], v85 offset:57856
  ds_read_b64_tr_b16 v[60:61], v84 offset:51200
  ds_read_b64_tr_b16 v[62:63], v84 offset:51712
  ds_read_b64_tr_b16 v[64:65], v85 offset:59392
  ds_read_b64_tr_b16 v[66:67], v85 offset:59904
  s_waitcnt lgkmcnt(4)
  v_mfma_f32_32x32x16_bf16 v[16:31], v[48:51], v[52:55], v[16:31]
  ds_read_b64_tr_b16 v[48:49], v84 offset:53248
  ds_read_b64_tr_b16 v[50:51], v84 offset:53760
  ds_read_b64_tr_b16 v[52:53], v85 offset:61440
  ds_read_b64_tr_b16 v[54:55], v85 offset:61952
  s_waitcnt lgkmcnt(4)
  v_mfma_f32_32x32x16_bf16 v[16:31], v[60:63], v[64:67], v[16:31]
  ds_read_b64_tr_b16 v[60:61], v84 offset:55296
  ds_read_b64_tr_b16 v[62:63], v84 offset:55808
  ds_read_b64_tr_b16 v[64:65], v85 offset:63488
  ds_read_b64_tr_b16 v[66:67], v85 offset:64000
  s_waitcnt lgkmcnt(4)
  v_mfma_f32_32x32x16_bf16 v[16:31], v[48:51], v[52:55], v[16:31]
  s_waitcnt lgkmcnt(0)
  v_mfma_f32_32x32x16_bf16 v[16:31], v[60:63], v[64:67], v[16:31]
  s_waitcnt vmcnt(8)
  s_barrier
  s_add_u32 m0, s40, 49152
  s_nop 0
  buffer_load_dwordx4 v72, s[16:19], s32 offen lds
  buffer_load_dwordx4 v73, s[16:19], s32 offen offset:1024 lds
  s_add_u32 s32, s32, 0x10000
  s_add_u32 m0, s40, 57344
  s_nop 0
  buffer_load_dwordx4 v74, s[8:11], s33 offen lds
  buffer_load_dwordx4 v75, s[8:11], s33 offen offset:1024 lds
  s_add_u32 s33, s33, 0x38000
  ds_read_b64_tr_b16 v[48:49], v84 offset:0
  ds_read_b64_tr_b16 v[50:51], v84 offset:512
  ds_read_b64_tr_b16 v[52:53], v85 offset:8192
  ds_read_b64_tr_b16 v[54:55], v85 offset:8704
  ds_read_b64_tr_b16 v[60:61], v84 offset:2048
  ds_read_b64_tr_b16 v[62:63], v84 offset:2560
  ds_read_b64_tr_b16 v[64:65], v85 offset:10240
  ds_read_b64_tr_b16 v[66:67], v85 offset:10752
  s_waitcnt lgkmcnt(4)
  v_mfma_f32_32x32x16_bf16 v[16:31], v[48:51], v[52:55], v[16:31]
  ds_read_b64_tr_b16 v[48:49], v84 offset:4096
  ds_read_b64_tr_b16 v[50:51], v84 offset:4608
  ds_read_b64_tr_b16 v[52:53], v85 offset:12288
  ds_read_b64_tr_b16 v[54:55], v85 offset:12800
  s_waitcnt lgkmcnt(4)
  v_mfma_f32_32x32x16_bf16 v[16:31], v[60:63], v[64:67], v[16:31]
  ds_read_b64_tr_b16 v[60:61], v84 offset:6144
  ds_read_b64_tr_b16 v[62:63], v84 offset:6656
  ds_read_b64_tr_b16 v[64:65], v85 offset:14336
  ds_read_b64_tr_b16 v[66:67], v85 offset:14848
  s_waitcnt lgkmcnt(4)
  v_mfma_f32_32x32x16_bf16 v[16:31], v[48:51], v[52:55], v[16:31]
  s_waitcnt lgkmcnt(0)
  v_mfma_f32_32x32x16_bf16 v[16:31], v[60:63], v[64:67], v[16:31]
  s_waitcnt vmcnt(8)
  s_barrier
  s_add_u32 m0, s40, 0
  s_nop 0
  buffer_load_dwordx4 v72, s[16:19], s32 offen lds
  buffer_load_dwordx4 v73, s[16:19], s32 offen offset:1024 lds
  s_add_u32 s32, s32, 0x10000
  s_add_u32 m0, s40, 8192
  s_nop 0
  buffer_load_dwordx4 v74, s[8:11], s33 offen lds
  buffer_load_dwordx4 v75, s[8:11], s33 offen offset:1024 lds
  s_add_u32 s33, s33, 0x38000
  ds_read_b64_tr_b16 v[48:49], v84 offset:16384
  ds_read_b64_tr_b16 v[50:51], v84 offset:16896
  ds_read_b64_tr_b16 v[52:53], v85 offset:24576
  ds_read_b64_tr_b16 v[54:55], v85 offset:25088
  ds_read_b64_tr_b16 v[60:61], v84 offset:18432
  ds_read_b64_tr_b16 v[62:63], v84 offset:18944
  ds_read_b64_tr_b16 v[64:65], v85 offset:26624
  ds_read_b64_tr_b16 v[66:67], v85 offset:27136
  s_waitcnt lgkmcnt(4)
  v_mfma_f32_32x32x16_bf16 v[16:31], v[48:51], v[52:55], v[16:31]
  ds_read_b64_tr_b16 v[48:49], v84 offset:20480
  ds_read_b64_tr_b16 v[50:51], v84 offset:20992
  ds_read_b64_tr_b16 v[52:53], v85 offset:28672
  ds_read_b64_tr_b16 v[54:55], v85 offset:29184
  s_waitcnt lgkmcnt(4)
  v_mfma_f32_32x32x16_bf16 v[16:31], v[60:63], v[64:67], v[16:31]
  ds_read_b64_tr_b16 v[60:61], v84 offset:22528
  ds_read_b64_tr_b16 v[62:63], v84 offset:23040
  ds_read_b64_tr_b16 v[64:65], v85 offset:30720
  ds_read_b64_tr_b16 v[66:67], v85 offset:31232
  s_waitcnt lgkmcnt(4)
  v_mfma_f32_32x32x16_bf16 v[16:31], v[48:51], v[52:55], v[16:31]
  s_waitcnt lgkmcnt(0)
  v_mfma_f32_32x32x16_bf16 v[16:31], v[60:63], v[64:67], v[16:31]
  s_waitcnt vmcnt(8)
  s_barrier
  s_add_u32 m0, s40, 16384
  s_nop 0
  buffer_load_dwordx4 v72, s[16:19], s32 offen lds
  buffer_load_dwordx4 v73, s[16:19], s32 offen offset:1024 lds
  s_add_u32 s32, s32, 0x10000
  s_add_u32 m0, s40, 24576
  s_nop 0
  buffer_load_dwordx4 v74, s[8:11], s33 offen lds
  buffer_load_dwordx4 v75, s[8:11], s33 offen offset:1024 lds
  s_add_u32 s33, s33, 0x38000
  ds_read_b64_tr_b16 v[48:49], v84 offset:32768
  ds_read_b64_tr_b16 v[50:51], v84 offset:33280
  ds_read_b64_tr_b16 v[52:53], v85 offset:40960
  ds_read_b64_tr_b16 v[54:55], v85 offset:41472
  ds_read_b64_tr_b16 v[60:61], v84 offset:34816
  ds_read_b64_tr_b16 v[62:63], v84 offset:35328
  ds_read_b64_tr_b16 v[64:65], v85 offset:43008
  ds_read_b64_tr_b16 v[66:67], v85 offset:43520
  s_waitcnt lgkmcnt(4)
  v_mfma_f32_32x32x16_bf16 v[16:31], v[48:51], v[52:55], v[16:31]
  ds_read_b64_tr_b16 v[48:49], v84 offset:36864
  ds_read_b64_tr_b16 v[50:51], v84 offset:37376
  ds_read_b64_tr_b16 v[52:53], v85 offset:45056
  ds_read_b64_tr_b16 v[54:55], v85 offset:45568
  s_waitcnt lgkmcnt(4)
  v_mfma_f32_32x32x16_bf16 v[16:31], v[60:63], v[64:67], v[16:31]
  ds_read_b64_tr_b16 v[60:61], v84 offset:38912
  ds_read_b64_tr_b16 v[62:63], v84 offset:39424
  ds_read_b64_tr_b16 v[64:65], v85 offset:47104
  ds_read_b64_tr_b16 v[66:67], v85 offset:47616
  s_waitcnt lgkmcnt(4)
  v_mfma_f32_32x32x16_bf16 v[16:31], v[48:51], v[52:55], v[16:31]
  s_waitcnt lgkmcnt(0)
  v_mfma_f32_32x32x16_bf16 v[16:31], v[60:63], v[64:67], v[16:31]
  s_waitcnt vmcnt(8)
  s_barrier
  s_add_u32 m0, s40, 32768
  s_nop 0
  buffer_load_dwordx4 v72, s[16:19], s32 offen lds
  buffer_load_dwordx4 v73, s[16:19], s32 offen offset:1024 lds
  s_add_u32 s32, s32, 0x10000
  s_add_u32 m0, s40, 40960
  s_nop 0
  buffer_load_dwordx4 v74, s[8:11], s33 offen lds
  buffer_load_dwordx4 v75, s[8:11], s33 offen offset:1024 lds
  s_add_u32 s33, s33, 0x38000
  ds_read_b64_tr_b16 v[48:49], v84 offset:49152
  ds_read_b64_tr_b16 v[50:51], v84 offset:49664
  ds_read_b64_tr_b16 v[52:53], v85 offset:57344
  ds_read_b64_tr_b16 v[54:55], v85 offset:57856
  ds_read_b64_tr_b16 v[60:61], v84 offset:51200
  ds_read_b64_tr_b16 v[62:63], v84 offset:51712
  ds_read_b64_tr_b16 v[64:65], v85 offset:59392
  ds_read_b64_tr_b16 v[66:67], v85 offset:59904
  s_waitcnt lgkmcnt(4)
  v_mfma_f32_32x32x16_bf16 v[16:31], v[48:51], v[52:55], v[16:31]
  ds_read_b64_tr_b16 v[48:49], v84 offset:53248
  ds_read_b64_tr_b16 v[50:51], v84 offset:53760
  ds_read_b64_tr_b16 v[52:53], v85 offset:61440
  ds_read_b64_tr_b16 v[54:55], v85 offset:61952
  s_waitcnt lgkmcnt(4)
  v_mfma_f32_32x32x16_bf16 v[16:31], v[60:63], v[64:67], v[16:31]
  ds_read_b64_tr_b16 v[60:61], v84 offset:55296
  ds_read_b64_tr_b16 v[62:63], v84 offset:55808
  ds_read_b64_tr_b16 v[64:65], v85 offset:63488
  ds_read_b64_tr_b16 v[66:67], v85 offset:64000
  s_waitcnt lgkmcnt(4)
  v_mfma_f32_32x32x16_bf16 v[16:31], v[48:51], v[52:55], v[16:31]
  s_waitcnt lgkmcnt(0)
  v_mfma_f32_32x32x16_bf16 v[16:31], v[60:63], v[64:67], v[16:31]
  s_waitcnt vmcnt(8)
  s_barrier
  s_add_u32 m0, s40, 49152
  s_nop 0
  buffer_load_dwordx4 v72, s[16:19], s32 offen lds
  buffer_load_dwordx4 v73, s[16:19], s32 offen offset:1024 lds
  s_add_u32 s32, s32, 0x10000
  s_add_u32 m0, s40, 57344
  s_nop 0
  buffer_load_dwordx4 v74, s[8:11], s33 offen lds
  buffer_load_dwordx4 v75, s[8:11], s33 offen offset:1024 lds
  s_add_u32 s33, s33, 0x38000
  ds_read_b64_tr_b16 v[48:49], v84 offset:0
  ds_read_b64_tr_b16 v[50:51], v84 offset:512
  ds_read_b64_tr_b16 v[52:53], v85 offset:8192
  ds_read_b64_tr_b16 v[54:55], v85 offset:8704
  ds_read_b64_tr_b16 v[60:61], v84 offset:2048
  ds_read_b64_tr_b16 v[62:63], v84 offset:2560
  ds_read_b64_tr_b16 v[64:65], v85 offset:10240
  ds_read_b64_tr_b16 v[66:67], v85 offset:10752
  s_waitcnt lgkmcnt(4)
  v_mfma_f32_32x32x16_bf16 v[16:31], v[48:51], v[52:55], v[16:31]
  ds_read_b64_tr_b16 v[48:49], v84 offset:4096
  ds_read_b64_tr_b16 v[50:51], v84 offset:4608
  ds_read_b64_tr_b16 v[52:53], v85 offset:12288
  ds_read_b64_tr_b16 v[54:55], v85 offset:12800
  s_waitcnt lgkmcnt(4)
  v_mfma_f32_32x32x16_bf16 v[16:31], v[60:63], v[64:67], v[16:31]
  ds_read_b64_tr_b16 v[60:61], v84 offset:6144
  ds_read_b64_tr_b16 v[62:63], v84 offset:6656
  ds_read_b64_tr_b16 v[64:65], v85 offset:14336
  ds_read_b64_tr_b16 v[66:67], v85 offset:14848
  s_waitcnt lgkmcnt(4)
  v_mfma_f32_32x32x16_bf16 v[16:31], v[48:51], v[52:55], v[16:31]
  s_waitcnt lgkmcnt(0)
  v_mfma_f32_32x32x16_bf16 v[16:31], v[60:63], v[64:67], v[16:31]
  s_waitcnt vmcnt(8)
  s_barrier
  ds_read_b64_tr_b16 v[48:49], v84 offset:16384
  ds_read_b64_tr_b16 v[50:51], v84 offset:16896
  ds_read_b64_tr_b16 v[52:53], v85 offset:24576
  ds_read_b64_tr_b16 v[54:55], v85 offset:25088
  ds_read_b64_tr_b16 v[60:61], v84 offset:18432
  ds_read_b64_tr_b16 v[62:63], v84 offset:18944
  ds_read_b64_tr_b16 v[64:65], v85 offset:26624
  ds_read_b64_tr_b16 v[66:67], v85 offset:27136
  s_waitcnt lgkmcnt(4)
  v_mfma_f32_32x32x16_bf16 v[16:31], v[48:51], v[52:55], v[16:31]
  ds_read_b64_tr_b16 v[48:49], v84 offset:20480
  ds_read_b64_tr_b16 v[50:51], v84 offset:20992
  ds_read_b64_tr_b16 v[52:53], v85 offset:28672
  ds_read_b64_tr_b16 v[54:55], v85 offset:29184
  s_waitcnt lgkmcnt(4)
  v_mfma_f32_32x32x16_bf16 v[16:31], v[60:63], v[64:67], v[16:31]
  ds_read_b64_tr_b16 v[60:61], v84 offset:22528
  ds_read_b64_tr_b16 v[62:63], v84 offset:23040
  ds_read_b64_tr_b16 v[64:65], v85 offset:30720
  ds_read_b64_tr_b16 v[66:67], v85 offset:31232
  s_waitcnt lgkmcnt(4)
  v_mfma_f32_32x32x16_bf16 v[16:31], v[48:51], v[52:55], v[16:31]
  s_waitcnt lgkmcnt(0)
  v_mfma_f32_32x32x16_bf16 v[16:31], v[60:63], v[64:67], v[16:31]
  s_waitcnt vmcnt(4)
  s_barrier
  ds_read_b64_tr_b16 v[48:49], v84 offset:32768
  ds_read_b64_tr_b16 v[50:51], v84 offset:33280
  ds_read_b64_tr_b16 v[52:53], v85 offset:40960
  ds_read_b64_tr_b16 v[54:55], v85 offset:41472
  ds_read_b64_tr_b16 v[60:61], v84 offset:34816
  ds_read_b64_tr_b16 v[62:63], v84 offset:35328
  ds_read_b64_tr_b16 v[64:65], v85 offset:43008
  ds_read_b64_tr_b16 v[66:67], v85 offset:43520
  s_waitcnt lgkmcnt(4)
  v_mfma_f32_32x32x16_bf16 v[16:31], v[48:51], v[52:55], v[16:31]
  ds_read_b64_tr_b16 v[48:49], v84 offset:36864
  ds_read_b64_tr_b16 v[50:51], v84 offset:37376
  ds_read_b64_tr_b16 v[52:53], v85 offset:45056
  ds_read_b64_tr_b16 v[54:55], v85 offset:45568
  s_waitcnt lgkmcnt(4)
  v_mfma_f32_32x32x16_bf16 v[16:31], v[60:63], v[64:67], v[16:31]
  ds_read_b64_tr_b16 v[60:61], v84 offset:38912
  ds_read_b64_tr_b16 v[62:63], v84 offset:39424
  ds_read_b64_tr_b16 v[64:65], v85 offset:47104
  ds_read_b64_tr_b16 v[66:67], v85 offset:47616
  s_waitcnt lgkmcnt(4)
  v_mfma_f32_32x32x16_bf16 v[16:31], v[48:51], v[52:55], v[16:31]
  s_waitcnt lgkmcnt(0)
  v_mfma_f32_32x32x16_bf16 v[16:31], v[60:63], v[64:67], v[16:31]
  s_waitcnt vmcnt(0)
  s_barrier
  ds_read_b64_tr_b16 v[48:49], v84 offset:49152
  ds_read_b64_tr_b16 v[50:51], v84 offset:49664
  ds_read_b64_tr_b16 v[52:53], v85 offset:57344
  ds_read_b64_tr_b16 v[54:55], v85 offset:57856
  ds_read_b64_tr_b16 v[60:61], v84 offset:51200
  ds_read_b64_tr_b16 v[62:63], v84 offset:51712
  ds_read_b64_tr_b16 v[64:65], v85 offset:59392
  ds_read_b64_tr_b16 v[66:67], v85 offset:59904
  s_waitcnt lgkmcnt(4)
  v_mfma_f32_32x32x16_bf16 v[16:31], v[48:51], v[52:55], v[16:31]
  ds_read_b64_tr_b16 v[48:49], v84 offset:53248
  ds_read_b64_tr_b16 v[50:51], v84 offset:53760
  ds_read_b64_tr_b16 v[52:53], v85 offset:61440
  ds_read_b64_tr_b16 v[54:55], v85 offset:61952
  s_waitcnt lgkmcnt(4)
  v_mfma_f32_32x32x16_bf16 v[16:31], v[60:63], v[64:67], v[16:31]
  ds_read_b64_tr_b16 v[60:61], v84 offset:55296
  ds_read_b64_tr_b16 v[62:63], v84 offset:55808
  ds_read_b64_tr_b16 v[64:65], v85 offset:63488
  ds_read_b64_tr_b16 v[66:67], v85 offset:64000
  s_waitcnt lgkmcnt(4)
  v_mfma_f32_32x32x16_bf16 v[16:31], v[48:51], v[52:55], v[16:31]
  s_waitcnt lgkmcnt(0)
  v_mfma_f32_32x32x16_bf16 v[16:31], v[60:63], v[64:67], v[16:31]
  s_nop 15
  s_nop 7
  v_lshlrev_b32 v110, 16, v110
  s_lshl_b32 s52, s49, 6
  s_lshl_b32 s53, s47, 5
  s_add_u32 s52, s52, s53
  v_lshl_add_u32 v4, v2, 2, s52
  s_movk_i32 s53, 3584
  v_mul_lo_u32 v4, v4, s53
  v_add_u32 v4, v4, v111
  s_mov_b32 s54, 0x400000
  s_mov_b32 s55, 0x3f4c422a
  s_mov_b32 s56, 0x3d372713
  s_mov_b32 s57, 0x4038aa3b
  v_cvt_pk_bf16_f32 v112, v16, v16
  v_lshlrev_b32 v16, 16, v112
  v_add_f32 v16, v16, v110
  v_cvt_pk_bf16_f32 v112, v16, v16
  v_lshlrev_b32 v16, 16, v112
  v_mul_f32 v112, v16, v16
  v_mul_f32 v112, v112, v16
  v_fma_f32 v112, s56, v112, v16
  v_mul_f32 v112, s55, v112
  v_mul_f32 v112, s57, v112
  v_exp_f32 v112, v112
  s_nop 0
  v_add_f32 v112, 1.0, v112
  v_rcp_f32 v112, v112
  s_nop 0
  v_fma_f32 v112, -2.0, v112, 1.0
  v_add_f32 v112, 1.0, v112
  v_mul_f32 v112, 0.5, v112
  v_mul_f32 v112, v112, v16
  v_cvt_pk_bf16_f32 v112, v112, v112
  v_add_u32 v113, 0x0, v4
  buffer_store_short v112, v113, s[16:19], s54 offen
  v_cvt_pk_bf16_f32 v112, v17, v17
  v_lshlrev_b32 v17, 16, v112
  v_add_f32 v17, v17, v110
  v_cvt_pk_bf16_f32 v112, v17, v17
  v_lshlrev_b32 v17, 16, v112
  v_mul_f32 v112, v17, v17
  v_mul_f32 v112, v112, v17
  v_fma_f32 v112, s56, v112, v17
  v_mul_f32 v112, s55, v112
  v_mul_f32 v112, s57, v112
  v_exp_f32 v112, v112
  s_nop 0
  v_add_f32 v112, 1.0, v112
  v_rcp_f32 v112, v112
  s_nop 0
  v_fma_f32 v112, -2.0, v112, 1.0
  v_add_f32 v112, 1.0, v112
  v_mul_f32 v112, 0.5, v112
  v_mul_f32 v112, v112, v17
  v_cvt_pk_bf16_f32 v112, v112, v112
  v_add_u32 v113, 0xe00, v4
  buffer_store_short v112, v113, s[16:19], s54 offen
  v_cvt_pk_bf16_f32 v112, v18, v18
  v_lshlrev_b32 v18, 16, v112
  v_add_f32 v18, v18, v110
  v_cvt_pk_bf16_f32 v112, v18, v18
  v_lshlrev_b32 v18, 16, v112
  v_mul_f32 v112, v18, v18
  v_mul_f32 v112, v112, v18
  v_fma_f32 v112, s56, v112, v18
  v_mul_f32 v112, s55, v112
  v_mul_f32 v112, s57, v112
  v_exp_f32 v112, v112
  s_nop 0
  v_add_f32 v112, 1.0, v112
  v_rcp_f32 v112, v112
  s_nop 0
  v_fma_f32 v112, -2.0, v112, 1.0
  v_add_f32 v112, 1.0, v112
  v_mul_f32 v112, 0.5, v112
  v_mul_f32 v112, v112, v18
  v_cvt_pk_bf16_f32 v112, v112, v112
  v_add_u32 v113, 0x1c00, v4
  buffer_store_short v112, v113, s[16:19], s54 offen
  v_cvt_pk_bf16_f32 v112, v19, v19
  v_lshlrev_b32 v19, 16, v112
  v_add_f32 v19, v19, v110
  v_cvt_pk_bf16_f32 v112, v19, v19
  v_lshlrev_b32 v19, 16, v112
  v_mul_f32 v112, v19, v19
  v_mul_f32 v112, v112, v19
  v_fma_f32 v112, s56, v112, v19
  v_mul_f32 v112, s55, v112
  v_mul_f32 v112, s57, v112
  v_exp_f32 v112, v112
  s_nop 0
  v_add_f32 v112, 1.0, v112
  v_rcp_f32 v112, v112
  s_nop 0
  v_fma_f32 v112, -2.0, v112, 1.0
  v_add_f32 v112, 1.0, v112
  v_mul_f32 v112, 0.5, v112
  v_mul_f32 v112, v112, v19
  v_cvt_pk_bf16_f32 v112, v112, v112
  v_add_u32 v113, 0x2a00, v4
  buffer_store_short v112, v113, s[16:19], s54 offen
  v_cvt_pk_bf16_f32 v112, v20, v20
  v_lshlrev_b32 v20, 16, v112
  v_add_f32 v20, v20, v110
  v_cvt_pk_bf16_f32 v112, v20, v20
  v_lshlrev_b32 v20, 16, v112
  v_mul_f32 v112, v20, v20
  v_mul_f32 v112, v112, v20
  v_fma_f32 v112, s56, v112, v20
  v_mul_f32 v112, s55, v112
  v_mul_f32 v112, s57, v112
  v_exp_f32 v112, v112
  s_nop 0
  v_add_f32 v112, 1.0, v112
  v_rcp_f32 v112, v112
  s_nop 0
  v_fma_f32 v112, -2.0, v112, 1.0
  v_add_f32 v112, 1.0, v112
  v_mul_f32 v112, 0.5, v112
  v_mul_f32 v112, v112, v20
  v_cvt_pk_bf16_f32 v112, v112, v112
  v_add_u32 v113, 0x7000, v4
  buffer_store_short v112, v113, s[16:19], s54 offen
  v_cvt_pk_bf16_f32 v112, v21, v21
  v_lshlrev_b32 v21, 16, v112
  v_add_f32 v21, v21, v110
  v_cvt_pk_bf16_f32 v112, v21, v21
  v_lshlrev_b32 v21, 16, v112
  v_mul_f32 v112, v21, v21
  v_mul_f32 v112, v112, v21
  v_fma_f32 v112, s56, v112, v21
  v_mul_f32 v112, s55, v112
  v_mul_f32 v112, s57, v112
  v_exp_f32 v112, v112
  s_nop 0
  v_add_f32 v112, 1.0, v112
  v_rcp_f32 v112, v112
  s_nop 0
  v_fma_f32 v112, -2.0, v112, 1.0
  v_add_f32 v112, 1.0, v112
  v_mul_f32 v112, 0.5, v112
  v_mul_f32 v112, v112, v21
  v_cvt_pk_bf16_f32 v112, v112, v112
  v_add_u32 v113, 0x7e00, v4
  buffer_store_short v112, v113, s[16:19], s54 offen
  v_cvt_pk_bf16_f32 v112, v22, v22
  v_lshlrev_b32 v22, 16, v112
  v_add_f32 v22, v22, v110
  v_cvt_pk_bf16_f32 v112, v22, v22
  v_lshlrev_b32 v22, 16, v112
  v_mul_f32 v112, v22, v22
  v_mul_f32 v112, v112, v22
  v_fma_f32 v112, s56, v112, v22
  v_mul_f32 v112, s55, v112
  v_mul_f32 v112, s57, v112
  v_exp_f32 v112, v112
  s_nop 0
  v_add_f32 v112, 1.0, v112
  v_rcp_f32 v112, v112
  s_nop 0
  v_fma_f32 v112, -2.0, v112, 1.0
  v_add_f32 v112, 1.0, v112
  v_mul_f32 v112, 0.5, v112
  v_mul_f32 v112, v112, v22
  v_cvt_pk_bf16_f32 v112, v112, v112
  v_add_u32 v113, 0x8c00, v4
  buffer_store_short v112, v113, s[16:19], s54 offen
  v_cvt_pk_bf16_f32 v112, v23, v23
  v_lshlrev_b32 v23, 16, v112
  v_add_f32 v23, v23, v110
  v_cvt_pk_bf16_f32 v112, v23, v23
  v_lshlrev_b32 v23, 16, v112
  v_mul_f32 v112, v23, v23
  v_mul_f32 v112, v112, v23
  v_fma_f32 v112, s56, v112, v23
  v_mul_f32 v112, s55, v112
  v_mul_f32 v112, s57, v112
  v_exp_f32 v112, v112
  s_nop 0
  v_add_f32 v112, 1.0, v112
  v_rcp_f32 v112, v112
  s_nop 0
  v_fma_f32 v112, -2.0, v112, 1.0
  v_add_f32 v112, 1.0, v112
  v_mul_f32 v112, 0.5, v112
  v_mul_f32 v112, v112, v23
  v_cvt_pk_bf16_f32 v112, v112, v112
  v_add_u32 v113, 0x9a00, v4
  buffer_store_short v112, v113, s[16:19], s54 offen
  v_cvt_pk_bf16_f32 v112, v24, v24
  v_lshlrev_b32 v24, 16, v112
  v_add_f32 v24, v24, v110
  v_cvt_pk_bf16_f32 v112, v24, v24
  v_lshlrev_b32 v24, 16, v112
  v_mul_f32 v112, v24, v24
  v_mul_f32 v112, v112, v24
  v_fma_f32 v112, s56, v112, v24
  v_mul_f32 v112, s55, v112
  v_mul_f32 v112, s57, v112
  v_exp_f32 v112, v112
  s_nop 0
  v_add_f32 v112, 1.0, v112
  v_rcp_f32 v112, v112
  s_nop 0
  v_fma_f32 v112, -2.0, v112, 1.0
  v_add_f32 v112, 1.0, v112
  v_mul_f32 v112, 0.5, v112
  v_mul_f32 v112, v112, v24
  v_cvt_pk_bf16_f32 v112, v112, v112
  v_add_u32 v113, 0xe000, v4
  buffer_store_short v112, v113, s[16:19], s54 offen
  v_cvt_pk_bf16_f32 v112, v25, v25
  v_lshlrev_b32 v25, 16, v112
  v_add_f32 v25, v25, v110
  v_cvt_pk_bf16_f32 v112, v25, v25
  v_lshlrev_b32 v25, 16, v112
  v_mul_f32 v112, v25, v25
  v_mul_f32 v112, v112, v25
  v_fma_f32 v112, s56, v112, v25
  v_mul_f32 v112, s55, v112
  v_mul_f32 v112, s57, v112
  v_exp_f32 v112, v112
  s_nop 0
  v_add_f32 v112, 1.0, v112
  v_rcp_f32 v112, v112
  s_nop 0
  v_fma_f32 v112, -2.0, v112, 1.0
  v_add_f32 v112, 1.0, v112
  v_mul_f32 v112, 0.5, v112
  v_mul_f32 v112, v112, v25
  v_cvt_pk_bf16_f32 v112, v112, v112
  v_add_u32 v113, 0xee00, v4
  buffer_store_short v112, v113, s[16:19], s54 offen
  v_cvt_pk_bf16_f32 v112, v26, v26
  v_lshlrev_b32 v26, 16, v112
  v_add_f32 v26, v26, v110
  v_cvt_pk_bf16_f32 v112, v26, v26
  v_lshlrev_b32 v26, 16, v112
  v_mul_f32 v112, v26, v26
  v_mul_f32 v112, v112, v26
  v_fma_f32 v112, s56, v112, v26
  v_mul_f32 v112, s55, v112
  v_mul_f32 v112, s57, v112
  v_exp_f32 v112, v112
  s_nop 0
  v_add_f32 v112, 1.0, v112
  v_rcp_f32 v112, v112
  s_nop 0
  v_fma_f32 v112, -2.0, v112, 1.0
  v_add_f32 v112, 1.0, v112
  v_mul_f32 v112, 0.5, v112
  v_mul_f32 v112, v112, v26
  v_cvt_pk_bf16_f32 v112, v112, v112
  v_add_u32 v113, 0xfc00, v4
  buffer_store_short v112, v113, s[16:19], s54 offen
  v_cvt_pk_bf16_f32 v112, v27, v27
  v_lshlrev_b32 v27, 16, v112
  v_add_f32 v27, v27, v110
  v_cvt_pk_bf16_f32 v112, v27, v27
  v_lshlrev_b32 v27, 16, v112
  v_mul_f32 v112, v27, v27
  v_mul_f32 v112, v112, v27
  v_fma_f32 v112, s56, v112, v27
  v_mul_f32 v112, s55, v112
  v_mul_f32 v112, s57, v112
  v_exp_f32 v112, v112
  s_nop 0
  v_add_f32 v112, 1.0, v112
  v_rcp_f32 v112, v112
  s_nop 0
  v_fma_f32 v112, -2.0, v112, 1.0
  v_add_f32 v112, 1.0, v112
  v_mul_f32 v112, 0.5, v112
  v_mul_f32 v112, v112, v27
  v_cvt_pk_bf16_f32 v112, v112, v112
  v_add_u32 v113, 0x10a00, v4
  buffer_store_short v112, v113, s[16:19], s54 offen
  v_cvt_pk_bf16_f32 v112, v28, v28
  v_lshlrev_b32 v28, 16, v112
  v_add_f32 v28, v28, v110
  v_cvt_pk_bf16_f32 v112, v28, v28
  v_lshlrev_b32 v28, 16, v112
  v_mul_f32 v112, v28, v28
  v_mul_f32 v112, v112, v28
  v_fma_f32 v112, s56, v112, v28
  v_mul_f32 v112, s55, v112
  v_mul_f32 v112, s57, v112
  v_exp_f32 v112, v112
  s_nop 0
  v_add_f32 v112, 1.0, v112
  v_rcp_f32 v112, v112
  s_nop 0
  v_fma_f32 v112, -2.0, v112, 1.0
  v_add_f32 v112, 1.0, v112
  v_mul_f32 v112, 0.5, v112
  v_mul_f32 v112, v112, v28
  v_cvt_pk_bf16_f32 v112, v112, v112
  v_add_u32 v113, 0x15000, v4
  buffer_store_short v112, v113, s[16:19], s54 offen
  v_cvt_pk_bf16_f32 v112, v29, v29
  v_lshlrev_b32 v29, 16, v112
  v_add_f32 v29, v29, v110
  v_cvt_pk_bf16_f32 v112, v29, v29
  v_lshlrev_b32 v29, 16, v112
  v_mul_f32 v112, v29, v29
  v_mul_f32 v112, v112, v29
  v_fma_f32 v112, s56, v112, v29
  v_mul_f32 v112, s55, v112
  v_mul_f32 v112, s57, v112
  v_exp_f32 v112, v112
  s_nop 0
  v_add_f32 v112, 1.0, v112
  v_rcp_f32 v112, v112
  s_nop 0
  v_fma_f32 v112, -2.0, v112, 1.0
  v_add_f32 v112, 1.0, v112
  v_mul_f32 v112, 0.5, v112
  v_mul_f32 v112, v112, v29
  v_cvt_pk_bf16_f32 v112, v112, v112
  v_add_u32 v113, 0x15e00, v4
  buffer_store_short v112, v113, s[16:19], s54 offen
  v_cvt_pk_bf16_f32 v112, v30, v30
  v_lshlrev_b32 v30, 16, v112
  v_add_f32 v30, v30, v110
  v_cvt_pk_bf16_f32 v112, v30, v30
  v_lshlrev_b32 v30, 16, v112
  v_mul_f32 v112, v30, v30
  v_mul_f32 v112, v112, v30
  v_fma_f32 v112, s56, v112, v30
  v_mul_f32 v112, s55, v112
  v_mul_f32 v112, s57, v112
  v_exp_f32 v112, v112
  s_nop 0
  v_add_f32 v112, 1.0, v112
  v_rcp_f32 v112, v112
  s_nop 0
  v_fma_f32 v112, -2.0, v112, 1.0
  v_add_f32 v112, 1.0, v112
  v_mul_f32 v112, 0.5, v112
  v_mul_f32 v112, v112, v30
  v_cvt_pk_bf16_f32 v112, v112, v112
  v_add_u32 v113, 0x16c00, v4
  buffer_store_short v112, v113, s[16:19], s54 offen
  v_cvt_pk_bf16_f32 v112, v31, v31
  v_lshlrev_b32 v31, 16, v112
  v_add_f32 v31, v31, v110
  v_cvt_pk_bf16_f32 v112, v31, v31
  v_lshlrev_b32 v31, 16, v112
  v_mul_f32 v112, v31, v31
  v_mul_f32 v112, v112, v31
  v_fma_f32 v112, s56, v112, v31
  v_mul_f32 v112, s55, v112
  v_mul_f32 v112, s57, v112
  v_exp_f32 v112, v112
  s_nop 0
  v_add_f32 v112, 1.0, v112
  v_rcp_f32 v112, v112
  s_nop 0
  v_fma_f32 v112, -2.0, v112, 1.0
  v_add_f32 v112, 1.0, v112
  v_mul_f32 v112, 0.5, v112
  v_mul_f32 v112, v112, v31
  v_cvt_pk_bf16_f32 v112, v112, v112
  v_add_u32 v113, 0x17a00, v4
  buffer_store_short v112, v113, s[16:19], s54 offen
  s_branch mid_end
mid_scan:
  s_load_dwordx2 s[20:21], s[0:1], 128
  s_mov_b32 s22, s2
  s_lshr_b32 s23, s22, 1
  s_and_b32 s24, s22, 1
  s_lshl_b32 s24, s24, 8
  v_add_u32 v1, s24, v0
  s_waitcnt lgkmcnt(0)
  s_mov_b32 s16, s20
  s_mov_b32 s17, s21
  s_mov_b32 s18, 0x10000000
  s_mov_b32 s19, 0x00020000
  v_lshlrev_b32 v2, 2, v1
  s_mov_b32 s25, 0x1400000
  v_add_u32 v3, 0, v2
  buffer_load_dword v4, v3, s[16:19], s25 offen
  v_add_u32 v3, 2048, v2
  buffer_load_dword v5, v3, s[16:19], s25 offen
  v_add_u32 v3, 8192, v2
  buffer_load_dword v6, v3, s[16:19], s25 offen
  v_add_u32 v3, 10240, v2
  buffer_load_dword v7, v3, s[16:19], s25 offen
  s_lshl_b32 s26, s23, 16
  s_add_u32 s27, s26, 0x600000
  s_add_u32 s28, s26, 0xa00000
  v_add_u32 v3, 0, v2
  buffer_load_dword v16, v3, s[16:19], s27 offen
  buffer_load_dword v48, v3, s[16:19], s28 offen
  v_add_u32 v3, 2048, v2
  buffer_load_dword v17, v3, s[16:19], s27 offen
  buffer_load_dword v49, v3, s[16:19], s28 offen
  v_add_u32 v3, 4096, v2
  buffer_load_dword v18, v3, s[16:19], s27 offen
  buffer_load_dword v50, v3, s[16:19], s28 offen
  v_add_u32 v3, 6144, v2
  buffer_load_dword v19, v3, s[16:19], s27 offen
  buffer_load_dword v51, v3, s[16:19], s28 offen
  v_add_u32 v3, 8192, v2
  buffer_load_dword v20, v3, s[16:19], s27 offen
  buffer_load_dword v52, v3, s[16:19], s28 offen
  v_add_u32 v3, 10240, v2
  buffer_load_dword v21, v3, s[16:19], s27 offen
  buffer_load_dword v53, v3, s[16:19], s28 offen
  v_add_u32 v3, 12288, v2
  buffer_load_dword v22, v3, s[16:19], s27 offen
  buffer_load_dword v54, v3, s[16:19], s28 offen
  v_add_u32 v3, 14336, v2
  buffer_load_dword v23, v3, s[16:19], s27 offen
  buffer_load_dword v55, v3, s[16:19], s28 offen
  v_add_u32 v3, 16384, v2
  buffer_load_dword v24, v3, s[16:19], s27 offen
  buffer_load_dword v56, v3, s[16:19], s28 offen
  v_add_u32 v3, 18432, v2
  buffer_load_dword v25, v3, s[16:19], s27 offen
  buffer_load_dword v57, v3, s[16:19], s28 offen
  v_add_u32 v3, 20480, v2
  buffer_load_dword v26, v3, s[16:19], s27 offen
  buffer_load_dword v58, v3, s[16:19], s28 offen
  v_add_u32 v3, 22528, v2
  buffer_load_dword v27, v3, s[16:19], s27 offen
  buffer_load_dword v59, v3, s[16:19], s28 offen
  v_add_u32 v3, 24576, v2
  buffer_load_dword v28, v3, s[16:19], s27 offen
  buffer_load_dword v60, v3, s[16:19], s28 offen
  v_add_u32 v3, 26624, v2
  buffer_load_dword v29, v3, s[16:19], s27 offen
  buffer_load_dword v61, v3, s[16:19], s28 offen
  v_add_u32 v3, 28672, v2
  buffer_load_dword v30, v3, s[16:19], s27 offen
  buffer_load_dword v62, v3, s[16:19], s28 offen
  v_add_u32 v3, 30720, v2
  buffer_load_dword v31, v3, s[16:19], s27 offen
  buffer_load_dword v63, v3, s[16:19], s28 offen
  v_add_u32 v3, 32768, v2
  buffer_load_dword v32, v3, s[16:19], s27 offen
  buffer_load_dword v64, v3, s[16:19], s28 offen
  v_add_u32 v3, 34816, v2
  buffer_load_dword v33, v3, s[16:19], s27 offen
  buffer_load_dword v65, v3, s[16:19], s28 offen
  v_add_u32 v3, 36864, v2
  buffer_load_dword v34, v3, s[16:19], s27 offen
  buffer_load_dword v66, v3, s[16:19], s28 offen
  v_add_u32 v3, 38912, v2
  buffer_load_dword v35, v3, s[16:19], s27 offen
  buffer_load_dword v67, v3, s[16:19], s28 offen
  v_add_u32 v3, 40960, v2
  buffer_load_dword v36, v3, s[16:19], s27 offen
  buffer_load_dword v68, v3, s[16:19], s28 offen
  v_add_u32 v3, 43008, v2
  buffer_load_dword v37, v3, s[16:19], s27 offen
  buffer_load_dword v69, v3, s[16:19], s28 offen
  v_add_u32 v3, 45056, v2
  buffer_load_dword v38, v3, s[16:19], s27 offen
  buffer_load_dword v70, v3, s[16:19], s28 offen
  v_add_u32 v3, 47104, v2
  buffer_load_dword v39, v3, s[16:19], s27 offen
  buffer_load_dword v71, v3, s[16:19], s28 offen
  v_add_u32 v3, 49152, v2
  buffer_load_dword v40, v3, s[16:19], s27 offen
  buffer_load_dword v72, v3, s[16:19], s28 offen
  v_add_u32 v3, 51200, v2
  buffer_load_dword v41, v3, s[16:19], s27 offen
  buffer_load_dword v73, v3, s[16:19], s28 offen
  v_add_u32 v3, 53248, v2
  buffer_load_dword v42, v3, s[16:19], s27 offen
  buffer_load_dword v74, v3, s[16:19], s28 offen
  v_add_u32 v3, 55296, v2
  buffer_load_dword v43, v3, s[16:19], s27 offen
  buffer_load_dword v75, v3, s[16:19], s28 offen
  v_add_u32 v3, 57344, v2
  buffer_load_dword v44, v3, s[16:19], s27 offen
  buffer_load_dword v76, v3, s[16:19], s28 offen
  v_add_u32 v3, 59392, v2
  buffer_load_dword v45, v3, s[16:19], s27 offen
  buffer_load_dword v77, v3, s[16:19], s28 offen
  v_add_u32 v3, 61440, v2
  buffer_load_dword v46, v3, s[16:19], s27 offen
  buffer_load_dword v78, v3, s[16:19], s28 offen
  v_add_u32 v3, 63488, v2
  buffer_load_dword v47, v3, s[16:19], s27 offen
  buffer_load_dword v79, v3, s[16:19], s28 offen
  v_mov_b32 v8, 0
  v_mov_b32 v9, 0
  v_lshlrev_b32 v3, 3, v1
  v_add_u32 v80, 4096, v3
  s_mov_b32 s29, 0xe00000
  s_mov_b32 s30, 0
mid_carry:
  s_cmp_ge_u32 s30, s23
  s_cbranch_scc1 mid_carry_done
  s_add_u32 s31, s29, 0
  buffer_load_dwordx2 v[84:85], v3, s[16:19], s31 offen
  buffer_load_dwordx2 v[86:87], v80, s[16:19], s31 offen
  s_add_u32 s31, s29, 8192
  buffer_load_dwordx2 v[88:89], v3, s[16:19], s31 offen
  buffer_load_dwordx2 v[90:91], v80, s[16:19], s31 offen
  s_add_u32 s31, s29, 16384
  buffer_load_dwordx2 v[92:93], v3, s[16:19], s31 offen
  buffer_load_dwordx2 v[94:95], v80, s[16:19], s31 offen
  s_add_u32 s31, s29, 24576
  buffer_load_dwordx2 v[96:97], v3, s[16:19], s31 offen
  buffer_load_dwordx2 v[98:99], v80, s[16:19], s31 offen
  s_add_u32 s31, s29, 32768
  buffer_load_dwordx2 v[100:101], v3, s[16:19], s31 offen
  buffer_load_dwordx2 v[102:103], v80, s[16:19], s31 offen
  s_add_u32 s31, s29, 40960
  buffer_load_dwordx2 v[104:105], v3, s[16:19], s31 offen
  buffer_load_dwordx2 v[106:107], v80, s[16:19], s31 offen
  s_add_u32 s31, s29, 49152
  buffer_load_dwordx2 v[108:109], v3, s[16:19], s31 offen
  buffer_load_dwordx2 v[110:111], v80, s[16:19], s31 offen
  s_add_u32 s31, s29, 57344
  buffer_load_dwordx2 v[112:113], v3, s[16:19], s31 offen
  buffer_load_dwordx2 v[114:115], v80, s[16:19], s31 offen
  s_add_u32 s31, s29, 65536
  buffer_load_dwordx2 v[116:117], v3, s[16:19], s31 offen
  buffer_load_dwordx2 v[118:119], v80, s[16:19], s31 offen
  s_add_u32 s31, s29, 73728
  buffer_load_dwordx2 v[120:121], v3, s[16:19], s31 offen
  buffer_load_dwordx2 v[122:123], v80, s[16:19], s31 offen
  s_add_u32 s31, s29, 81920
  buffer_load_dwordx2 v[124:125], v3, s[16:19], s31 offen
  buffer_load_dwordx2 v[126:127], v80, s[16:19], s31 offen
  s_add_u32 s31, s29, 90112
  buffer_load_dwordx2 v[128:129], v3, s[16:19], s31 offen
  buffer_load_dwordx2 v[130:131], v80, s[16:19], s31 offen
  s_add_u32 s31, s29, 98304
  buffer_load_dwordx2 v[132:133], v3, s[16:19], s31 offen
  buffer_load_dwordx2 v[134:135], v80, s[16:19], s31 offen
  s_add_u32 s31, s29, 106496
  buffer_load_dwordx2 v[136:137], v3, s[16:19], s31 offen
  buffer_load_dwordx2 v[138:139], v80, s[16:19], s31 offen
  s_add_u32 s31, s29, 114688
  buffer_load_dwordx2 v[140:141], v3, s[16:19], s31 offen
  buffer_load_dwordx2 v[142:143], v80, s[16:19], s31 offen
  s_add_u32 s31, s29, 122880
  buffer_load_dwordx2 v[144:145], v3, s[16:19], s31 offen
  buffer_load_dwordx2 v[146:147], v80, s[16:19], s31 offen
  s_waitcnt vmcnt(0)
  v_add_f32 v10, v84, v86
  v_add_f32 v11, v85, v87
  v_fma_f32 v14, v6, v8, v10
  v_fma_f32 v15, v6, v9, v11
  v_fma_f32 v14, -v7, v9, v14
  v_fma_f32 v9, v7, v8, v15
  v_mov_b32 v8, v14
  s_add_u32 s30, s30, 1
  s_cmp_ge_u32 s30, s23
  s_cbranch_scc1 mid_carry_done
  v_add_f32 v10, v88, v90
  v_add_f32 v11, v89, v91
  v_fma_f32 v14, v6, v8, v10
  v_fma_f32 v15, v6, v9, v11
  v_fma_f32 v14, -v7, v9, v14
  v_fma_f32 v9, v7, v8, v15
  v_mov_b32 v8, v14
  s_add_u32 s30, s30, 1
  s_cmp_ge_u32 s30, s23
  s_cbranch_scc1 mid_carry_done
  v_add_f32 v10, v92, v94
  v_add_f32 v11, v93, v95
  v_fma_f32 v14, v6, v8, v10
  v_fma_f32 v15, v6, v9, v11
  v_fma_f32 v14, -v7, v9, v14
  v_fma_f32 v9, v7, v8, v15
  v_mov_b32 v8, v14
  s_add_u32 s30, s30, 1
  s_cmp_ge_u32 s30, s23
  s_cbranch_scc1 mid_carry_done
  v_add_f32 v10, v96, v98
  v_add_f32 v11, v97, v99
  v_fma_f32 v14, v6, v8, v10
  v_fma_f32 v15, v6, v9, v11
  v_fma_f32 v14, -v7, v9, v14
  v_fma_f32 v9, v7, v8, v15
  v_mov_b32 v8, v14
  s_add_u32 s30, s30, 1
  s_cmp_ge_u32 s30, s23
  s_cbranch_scc1 mid_carry_done
  v_add_f32 v10, v100, v102
  v_add_f32 v11, v101, v103
  v_fma_f32 v14, v6, v8, v10
  v_fma_f32 v15, v6, v9, v11
  v_fma_f32 v14, -v7, v9, v14
  v_fma_f32 v9, v7, v8, v15
  v_mov_b32 v8, v14
  s_add_u32 s30, s30, 1
  s_cmp_ge_u32 s30, s23
  s_cbranch_scc1 mid_carry_done
  v_add_f32 v10, v104, v106
  v_add_f32 v11, v105, v107
  v_fma_f32 v14, v6, v8, v10
  v_fma_f32 v15, v6, v9, v11
  v_fma_f32 v14, -v7, v9, v14
  v_fma_f32 v9, v7, v8, v15
  v_mov_b32 v8, v14
  s_add_u32 s30, s30, 1
  s_cmp_ge_u32 s30, s23
  s_cbranch_scc1 mid_carry_done
  v_add_f32 v10, v108, v110
  v_add_f32 v11, v109, v111
  v_fma_f32 v14, v6, v8, v10
  v_fma_f32 v15, v6, v9, v11
  v_fma_f32 v14, -v7, v9, v14
  v_fma_f32 v9, v7, v8, v15
  v_mov_b32 v8, v14
  s_add_u32 s30, s30, 1
  s_cmp_ge_u32 s30, s23
  s_cbranch_scc1 mid_carry_done
  v_add_f32 v10, v112, v114
  v_add_f32 v11, v113, v115
  v_fma_f32 v14, v6, v8, v10
  v_fma_f32 v15, v6, v9, v11
  v_fma_f32 v14, -v7, v9, v14
  v_fma_f32 v9, v7, v8, v15
  v_mov_b32 v8, v14
  s_add_u32 s30, s30, 1
  s_cmp_ge_u32 s30, s23
  s_cbranch_scc1 mid_carry_done
  v_add_f32 v10, v116, v118
  v_add_f32 v11, v117, v119
  v_fma_f32 v14, v6, v8, v10
  v_fma_f32 v15, v6, v9, v11
  v_fma_f32 v14, -v7, v9, v14
  v_fma_f32 v9, v7, v8, v15
  v_mov_b32 v8, v14
  s_add_u32 s30, s30, 1
  s_cmp_ge_u32 s30, s23
  s_cbranch_scc1 mid_carry_done
  v_add_f32 v10, v120, v122
  v_add_f32 v11, v121, v123
  v_fma_f32 v14, v6, v8, v10
  v_fma_f32 v15, v6, v9, v11
  v_fma_f32 v14, -v7, v9, v14
  v_fma_f32 v9, v7, v8, v15
  v_mov_b32 v8, v14
  s_add_u32 s30, s30, 1
  s_cmp_ge_u32 s30, s23
  s_cbranch_scc1 mid_carry_done
  v_add_f32 v10, v124, v126
  v_add_f32 v11, v125, v127
  v_fma_f32 v14, v6, v8, v10
  v_fma_f32 v15, v6, v9, v11
  v_fma_f32 v14, -v7, v9, v14
  v_fma_f32 v9, v7, v8, v15
  v_mov_b32 v8, v14
  s_add_u32 s30, s30, 1
  s_cmp_ge_u32 s30, s23
  s_cbranch_scc1 mid_carry_done
  v_add_f32 v10, v128, v130
  v_add_f32 v11, v129, v131
  v_fma_f32 v14, v6, v8, v10
  v_fma_f32 v15, v6, v9, v11
  v_fma_f32 v14, -v7, v9, v14
  v_fma_f32 v9, v7, v8, v15
  v_mov_b32 v8, v14
  s_add_u32 s30, s30, 1
  s_cmp_ge_u32 s30, s23
  s_cbranch_scc1 mid_carry_done
  v_add_f32 v10, v132, v134
  v_add_f32 v11, v133, v135
  v_fma_f32 v14, v6, v8, v10
  v_fma_f32 v15, v6, v9, v11
  v_fma_f32 v14, -v7, v9, v14
  v_fma_f32 v9, v7, v8, v15
  v_mov_b32 v8, v14
  s_add_u32 s30, s30, 1
  s_cmp_ge_u32 s30, s23
  s_cbranch_scc1 mid_carry_done
  v_add_f32 v10, v136, v138
  v_add_f32 v11, v137, v139
  v_fma_f32 v14, v6, v8, v10
  v_fma_f32 v15, v6, v9, v11
  v_fma_f32 v14, -v7, v9, v14
  v_fma_f32 v9, v7, v8, v15
  v_mov_b32 v8, v14
  s_add_u32 s30, s30, 1
  s_cmp_ge_u32 s30, s23
  s_cbranch_scc1 mid_carry_done
  v_add_f32 v10, v140, v142
  v_add_f32 v11, v141, v143
  v_fma_f32 v14, v6, v8, v10
  v_fma_f32 v15, v6, v9, v11
  v_fma_f32 v14, -v7, v9, v14
  v_fma_f32 v9, v7, v8, v15
  v_mov_b32 v8, v14
  s_add_u32 s30, s30, 1
  s_cmp_ge_u32 s30, s23
  s_cbranch_scc1 mid_carry_done
  v_add_f32 v10, v144, v146
  v_add_f32 v11, v145, v147
  v_fma_f32 v14, v6, v8, v10
  v_fma_f32 v15, v6, v9, v11
  v_fma_f32 v14, -v7, v9, v14
  v_fma_f32 v9, v7, v8, v15
  v_mov_b32 v8, v14
  s_add_u32 s30, s30, 1
  s_add_u32 s29, s29, 131072
  s_branch mid_carry
mid_carry_done:
  s_waitcnt vmcnt(0)
  s_lshl_b32 s26, s23, 16
  s_add_u32 s26, s26, 0x1000000
  v_lshlrev_b32 v3, 1, v1
  v_fma_f32 v14, v4, v8, v16
  v_fma_f32 v15, v4, v9, v48
  v_fma_f32 v14, -v5, v9, v14
  v_fma_f32 v9, v5, v8, v15
  v_mov_b32 v8, v14
  v_cvt_pk_bf16_f32 v10, v8, v8
  v_xor_b32 v11, 0x80000000, v9
  v_cvt_pk_bf16_f32 v11, v11, v11
  v_add_u32 v12, 0, v3
  buffer_store_short v10, v12, s[16:19], s26 offen
  buffer_store_short v11, v12, s[16:19], s26 offen offset:1024
  v_fma_f32 v14, v4, v8, v17
  v_fma_f32 v15, v4, v9, v49
  v_fma_f32 v14, -v5, v9, v14
  v_fma_f32 v9, v5, v8, v15
  v_mov_b32 v8, v14
  v_cvt_pk_bf16_f32 v10, v8, v8
  v_xor_b32 v11, 0x80000000, v9
  v_cvt_pk_bf16_f32 v11, v11, v11
  v_add_u32 v12, 2048, v3
  buffer_store_short v10, v12, s[16:19], s26 offen
  buffer_store_short v11, v12, s[16:19], s26 offen offset:1024
  v_fma_f32 v14, v4, v8, v18
  v_fma_f32 v15, v4, v9, v50
  v_fma_f32 v14, -v5, v9, v14
  v_fma_f32 v9, v5, v8, v15
  v_mov_b32 v8, v14
  v_cvt_pk_bf16_f32 v10, v8, v8
  v_xor_b32 v11, 0x80000000, v9
  v_cvt_pk_bf16_f32 v11, v11, v11
  v_add_u32 v12, 4096, v3
  buffer_store_short v10, v12, s[16:19], s26 offen
  buffer_store_short v11, v12, s[16:19], s26 offen offset:1024
  v_fma_f32 v14, v4, v8, v19
  v_fma_f32 v15, v4, v9, v51
  v_fma_f32 v14, -v5, v9, v14
  v_fma_f32 v9, v5, v8, v15
  v_mov_b32 v8, v14
  v_cvt_pk_bf16_f32 v10, v8, v8
  v_xor_b32 v11, 0x80000000, v9
  v_cvt_pk_bf16_f32 v11, v11, v11
  v_add_u32 v12, 6144, v3
  buffer_store_short v10, v12, s[16:19], s26 offen
  buffer_store_short v11, v12, s[16:19], s26 offen offset:1024
  v_fma_f32 v14, v4, v8, v20
  v_fma_f32 v15, v4, v9, v52
  v_fma_f32 v14, -v5, v9, v14
  v_fma_f32 v9, v5, v8, v15
  v_mov_b32 v8, v14
  v_cvt_pk_bf16_f32 v10, v8, v8
  v_xor_b32 v11, 0x80000000, v9
  v_cvt_pk_bf16_f32 v11, v11, v11
  v_add_u32 v12, 8192, v3
  buffer_store_short v10, v12, s[16:19], s26 offen
  buffer_store_short v11, v12, s[16:19], s26 offen offset:1024
  v_fma_f32 v14, v4, v8, v21
  v_fma_f32 v15, v4, v9, v53
  v_fma_f32 v14, -v5, v9, v14
  v_fma_f32 v9, v5, v8, v15
  v_mov_b32 v8, v14
  v_cvt_pk_bf16_f32 v10, v8, v8
  v_xor_b32 v11, 0x80000000, v9
  v_cvt_pk_bf16_f32 v11, v11, v11
  v_add_u32 v12, 10240, v3
  buffer_store_short v10, v12, s[16:19], s26 offen
  buffer_store_short v11, v12, s[16:19], s26 offen offset:1024
  v_fma_f32 v14, v4, v8, v22
  v_fma_f32 v15, v4, v9, v54
  v_fma_f32 v14, -v5, v9, v14
  v_fma_f32 v9, v5, v8, v15
  v_mov_b32 v8, v14
  v_cvt_pk_bf16_f32 v10, v8, v8
  v_xor_b32 v11, 0x80000000, v9
  v_cvt_pk_bf16_f32 v11, v11, v11
  v_add_u32 v12, 12288, v3
  buffer_store_short v10, v12, s[16:19], s26 offen
  buffer_store_short v11, v12, s[16:19], s26 offen offset:1024
  v_fma_f32 v14, v4, v8, v23
  v_fma_f32 v15, v4, v9, v55
  v_fma_f32 v14, -v5, v9, v14
  v_fma_f32 v9, v5, v8, v15
  v_mov_b32 v8, v14
  v_cvt_pk_bf16_f32 v10, v8, v8
  v_xor_b32 v11, 0x80000000, v9
  v_cvt_pk_bf16_f32 v11, v11, v11
  v_add_u32 v12, 14336, v3
  buffer_store_short v10, v12, s[16:19], s26 offen
  buffer_store_short v11, v12, s[16:19], s26 offen offset:1024
  v_fma_f32 v14, v4, v8, v24
  v_fma_f32 v15, v4, v9, v56
  v_fma_f32 v14, -v5, v9, v14
  v_fma_f32 v9, v5, v8, v15
  v_mov_b32 v8, v14
  v_cvt_pk_bf16_f32 v10, v8, v8
  v_xor_b32 v11, 0x80000000, v9
  v_cvt_pk_bf16_f32 v11, v11, v11
  v_add_u32 v12, 16384, v3
  buffer_store_short v10, v12, s[16:19], s26 offen
  buffer_store_short v11, v12, s[16:19], s26 offen offset:1024
  v_fma_f32 v14, v4, v8, v25
  v_fma_f32 v15, v4, v9, v57
  v_fma_f32 v14, -v5, v9, v14
  v_fma_f32 v9, v5, v8, v15
  v_mov_b32 v8, v14
  v_cvt_pk_bf16_f32 v10, v8, v8
  v_xor_b32 v11, 0x80000000, v9
  v_cvt_pk_bf16_f32 v11, v11, v11
  v_add_u32 v12, 18432, v3
  buffer_store_short v10, v12, s[16:19], s26 offen
  buffer_store_short v11, v12, s[16:19], s26 offen offset:1024
  v_fma_f32 v14, v4, v8, v26
  v_fma_f32 v15, v4, v9, v58
  v_fma_f32 v14, -v5, v9, v14
  v_fma_f32 v9, v5, v8, v15
  v_mov_b32 v8, v14
  v_cvt_pk_bf16_f32 v10, v8, v8
  v_xor_b32 v11, 0x80000000, v9
  v_cvt_pk_bf16_f32 v11, v11, v11
  v_add_u32 v12, 20480, v3
  buffer_store_short v10, v12, s[16:19], s26 offen
  buffer_store_short v11, v12, s[16:19], s26 offen offset:1024
  v_fma_f32 v14, v4, v8, v27
  v_fma_f32 v15, v4, v9, v59
  v_fma_f32 v14, -v5, v9, v14
  v_fma_f32 v9, v5, v8, v15
  v_mov_b32 v8, v14
  v_cvt_pk_bf16_f32 v10, v8, v8
  v_xor_b32 v11, 0x80000000, v9
  v_cvt_pk_bf16_f32 v11, v11, v11
  v_add_u32 v12, 22528, v3
  buffer_store_short v10, v12, s[16:19], s26 offen
  buffer_store_short v11, v12, s[16:19], s26 offen offset:1024
  v_fma_f32 v14, v4, v8, v28
  v_fma_f32 v15, v4, v9, v60
  v_fma_f32 v14, -v5, v9, v14
  v_fma_f32 v9, v5, v8, v15
  v_mov_b32 v8, v14
  v_cvt_pk_bf16_f32 v10, v8, v8
  v_xor_b32 v11, 0x80000000, v9
  v_cvt_pk_bf16_f32 v11, v11, v11
  v_add_u32 v12, 24576, v3
  buffer_store_short v10, v12, s[16:19], s26 offen
  buffer_store_short v11, v12, s[16:19], s26 offen offset:1024
  v_fma_f32 v14, v4, v8, v29
  v_fma_f32 v15, v4, v9, v61
  v_fma_f32 v14, -v5, v9, v14
  v_fma_f32 v9, v5, v8, v15
  v_mov_b32 v8, v14
  v_cvt_pk_bf16_f32 v10, v8, v8
  v_xor_b32 v11, 0x80000000, v9
  v_cvt_pk_bf16_f32 v11, v11, v11
  v_add_u32 v12, 26624, v3
  buffer_store_short v10, v12, s[16:19], s26 offen
  buffer_store_short v11, v12, s[16:19], s26 offen offset:1024
  v_fma_f32 v14, v4, v8, v30
  v_fma_f32 v15, v4, v9, v62
  v_fma_f32 v14, -v5, v9, v14
  v_fma_f32 v9, v5, v8, v15
  v_mov_b32 v8, v14
  v_cvt_pk_bf16_f32 v10, v8, v8
  v_xor_b32 v11, 0x80000000, v9
  v_cvt_pk_bf16_f32 v11, v11, v11
  v_add_u32 v12, 28672, v3
  buffer_store_short v10, v12, s[16:19], s26 offen
  buffer_store_short v11, v12, s[16:19], s26 offen offset:1024
  v_fma_f32 v14, v4, v8, v31
  v_fma_f32 v15, v4, v9, v63
  v_fma_f32 v14, -v5, v9, v14
  v_fma_f32 v9, v5, v8, v15
  v_mov_b32 v8, v14
  v_cvt_pk_bf16_f32 v10, v8, v8
  v_xor_b32 v11, 0x80000000, v9
  v_cvt_pk_bf16_f32 v11, v11, v11
  v_add_u32 v12, 30720, v3
  buffer_store_short v10, v12, s[16:19], s26 offen
  buffer_store_short v11, v12, s[16:19], s26 offen offset:1024
  v_fma_f32 v14, v4, v8, v32
  v_fma_f32 v15, v4, v9, v64
  v_fma_f32 v14, -v5, v9, v14
  v_fma_f32 v9, v5, v8, v15
  v_mov_b32 v8, v14
  v_cvt_pk_bf16_f32 v10, v8, v8
  v_xor_b32 v11, 0x80000000, v9
  v_cvt_pk_bf16_f32 v11, v11, v11
  v_add_u32 v12, 32768, v3
  buffer_store_short v10, v12, s[16:19], s26 offen
  buffer_store_short v11, v12, s[16:19], s26 offen offset:1024
  v_fma_f32 v14, v4, v8, v33
  v_fma_f32 v15, v4, v9, v65
  v_fma_f32 v14, -v5, v9, v14
  v_fma_f32 v9, v5, v8, v15
  v_mov_b32 v8, v14
  v_cvt_pk_bf16_f32 v10, v8, v8
  v_xor_b32 v11, 0x80000000, v9
  v_cvt_pk_bf16_f32 v11, v11, v11
  v_add_u32 v12, 34816, v3
  buffer_store_short v10, v12, s[16:19], s26 offen
  buffer_store_short v11, v12, s[16:19], s26 offen offset:1024
  v_fma_f32 v14, v4, v8, v34
  v_fma_f32 v15, v4, v9, v66
  v_fma_f32 v14, -v5, v9, v14
  v_fma_f32 v9, v5, v8, v15
  v_mov_b32 v8, v14
  v_cvt_pk_bf16_f32 v10, v8, v8
  v_xor_b32 v11, 0x80000000, v9
  v_cvt_pk_bf16_f32 v11, v11, v11
  v_add_u32 v12, 36864, v3
  buffer_store_short v10, v12, s[16:19], s26 offen
  buffer_store_short v11, v12, s[16:19], s26 offen offset:1024
  v_fma_f32 v14, v4, v8, v35
  v_fma_f32 v15, v4, v9, v67
  v_fma_f32 v14, -v5, v9, v14
  v_fma_f32 v9, v5, v8, v15
  v_mov_b32 v8, v14
  v_cvt_pk_bf16_f32 v10, v8, v8
  v_xor_b32 v11, 0x80000000, v9
  v_cvt_pk_bf16_f32 v11, v11, v11
  v_add_u32 v12, 38912, v3
  buffer_store_short v10, v12, s[16:19], s26 offen
  buffer_store_short v11, v12, s[16:19], s26 offen offset:1024
  v_fma_f32 v14, v4, v8, v36
  v_fma_f32 v15, v4, v9, v68
  v_fma_f32 v14, -v5, v9, v14
  v_fma_f32 v9, v5, v8, v15
  v_mov_b32 v8, v14
  v_cvt_pk_bf16_f32 v10, v8, v8
  v_xor_b32 v11, 0x80000000, v9
  v_cvt_pk_bf16_f32 v11, v11, v11
  v_add_u32 v12, 40960, v3
  buffer_store_short v10, v12, s[16:19], s26 offen
  buffer_store_short v11, v12, s[16:19], s26 offen offset:1024
  v_fma_f32 v14, v4, v8, v37
  v_fma_f32 v15, v4, v9, v69
  v_fma_f32 v14, -v5, v9, v14
  v_fma_f32 v9, v5, v8, v15
  v_mov_b32 v8, v14
  v_cvt_pk_bf16_f32 v10, v8, v8
  v_xor_b32 v11, 0x80000000, v9
  v_cvt_pk_bf16_f32 v11, v11, v11
  v_add_u32 v12, 43008, v3
  buffer_store_short v10, v12, s[16:19], s26 offen
  buffer_store_short v11, v12, s[16:19], s26 offen offset:1024
  v_fma_f32 v14, v4, v8, v38
  v_fma_f32 v15, v4, v9, v70
  v_fma_f32 v14, -v5, v9, v14
  v_fma_f32 v9, v5, v8, v15
  v_mov_b32 v8, v14
  v_cvt_pk_bf16_f32 v10, v8, v8
  v_xor_b32 v11, 0x80000000, v9
  v_cvt_pk_bf16_f32 v11, v11, v11
  v_add_u32 v12, 45056, v3
  buffer_store_short v10, v12, s[16:19], s26 offen
  buffer_store_short v11, v12, s[16:19], s26 offen offset:1024
  v_fma_f32 v14, v4, v8, v39
  v_fma_f32 v15, v4, v9, v71
  v_fma_f32 v14, -v5, v9, v14
  v_fma_f32 v9, v5, v8, v15
  v_mov_b32 v8, v14
  v_cvt_pk_bf16_f32 v10, v8, v8
  v_xor_b32 v11, 0x80000000, v9
  v_cvt_pk_bf16_f32 v11, v11, v11
  v_add_u32 v12, 47104, v3
  buffer_store_short v10, v12, s[16:19], s26 offen
  buffer_store_short v11, v12, s[16:19], s26 offen offset:1024
  v_fma_f32 v14, v4, v8, v40
  v_fma_f32 v15, v4, v9, v72
  v_fma_f32 v14, -v5, v9, v14
  v_fma_f32 v9, v5, v8, v15
  v_mov_b32 v8, v14
  v_cvt_pk_bf16_f32 v10, v8, v8
  v_xor_b32 v11, 0x80000000, v9
  v_cvt_pk_bf16_f32 v11, v11, v11
  v_add_u32 v12, 49152, v3
  buffer_store_short v10, v12, s[16:19], s26 offen
  buffer_store_short v11, v12, s[16:19], s26 offen offset:1024
  v_fma_f32 v14, v4, v8, v41
  v_fma_f32 v15, v4, v9, v73
  v_fma_f32 v14, -v5, v9, v14
  v_fma_f32 v9, v5, v8, v15
  v_mov_b32 v8, v14
  v_cvt_pk_bf16_f32 v10, v8, v8
  v_xor_b32 v11, 0x80000000, v9
  v_cvt_pk_bf16_f32 v11, v11, v11
  v_add_u32 v12, 51200, v3
  buffer_store_short v10, v12, s[16:19], s26 offen
  buffer_store_short v11, v12, s[16:19], s26 offen offset:1024
  v_fma_f32 v14, v4, v8, v42
  v_fma_f32 v15, v4, v9, v74
  v_fma_f32 v14, -v5, v9, v14
  v_fma_f32 v9, v5, v8, v15
  v_mov_b32 v8, v14
  v_cvt_pk_bf16_f32 v10, v8, v8
  v_xor_b32 v11, 0x80000000, v9
  v_cvt_pk_bf16_f32 v11, v11, v11
  v_add_u32 v12, 53248, v3
  buffer_store_short v10, v12, s[16:19], s26 offen
  buffer_store_short v11, v12, s[16:19], s26 offen offset:1024
  v_fma_f32 v14, v4, v8, v43
  v_fma_f32 v15, v4, v9, v75
  v_fma_f32 v14, -v5, v9, v14
  v_fma_f32 v9, v5, v8, v15
  v_mov_b32 v8, v14
  v_cvt_pk_bf16_f32 v10, v8, v8
  v_xor_b32 v11, 0x80000000, v9
  v_cvt_pk_bf16_f32 v11, v11, v11
  v_add_u32 v12, 55296, v3
  buffer_store_short v10, v12, s[16:19], s26 offen
  buffer_store_short v11, v12, s[16:19], s26 offen offset:1024
  v_fma_f32 v14, v4, v8, v44
  v_fma_f32 v15, v4, v9, v76
  v_fma_f32 v14, -v5, v9, v14
  v_fma_f32 v9, v5, v8, v15
  v_mov_b32 v8, v14
  v_cvt_pk_bf16_f32 v10, v8, v8
  v_xor_b32 v11, 0x80000000, v9
  v_cvt_pk_bf16_f32 v11, v11, v11
  v_add_u32 v12, 57344, v3
  buffer_store_short v10, v12, s[16:19], s26 offen
  buffer_store_short v11, v12, s[16:19], s26 offen offset:1024
  v_fma_f32 v14, v4, v8, v45
  v_fma_f32 v15, v4, v9, v77
  v_fma_f32 v14, -v5, v9, v14
  v_fma_f32 v9, v5, v8, v15
  v_mov_b32 v8, v14
  v_cvt_pk_bf16_f32 v10, v8, v8
  v_xor_b32 v11, 0x80000000, v9
  v_cvt_pk_bf16_f32 v11, v11, v11
  v_add_u32 v12, 59392, v3
  buffer_store_short v10, v12, s[16:19], s26 offen
  buffer_store_short v11, v12, s[16:19], s26 offen offset:1024
  v_fma_f32 v14, v4, v8, v46
  v_fma_f32 v15, v4, v9, v78
  v_fma_f32 v14, -v5, v9, v14
  v_fma_f32 v9, v5, v8, v15
  v_mov_b32 v8, v14
  v_cvt_pk_bf16_f32 v10, v8, v8
  v_xor_b32 v11, 0x80000000, v9
  v_cvt_pk_bf16_f32 v11, v11, v11
  v_add_u32 v12, 61440, v3
  buffer_store_short v10, v12, s[16:19], s26 offen
  buffer_store_short v11, v12, s[16:19], s26 offen offset:1024
  v_fma_f32 v14, v4, v8, v47
  v_fma_f32 v15, v4, v9, v79
  v_fma_f32 v14, -v5, v9, v14
  v_fma_f32 v9, v5, v8, v15
  v_mov_b32 v8, v14
  v_cvt_pk_bf16_f32 v10, v8, v8
  v_xor_b32 v11, 0x80000000, v9
  v_cvt_pk_bf16_f32 v11, v11, v11
  v_add_u32 v12, 63488, v3
  buffer_store_short v10, v12, s[16:19], s26 offen
  buffer_store_short v11, v12, s[16:19], s26 offen offset:1024
mid_end:
  s_endpgm
.globl fin_kernel
.p2align 8
.type fin_kernel,@function
fin_kernel:
  s_cmp_ge_u32 s2, 256
  s_cbranch_scc1 fin_end
  s_load_dwordx2 s[4:5], s[0:1], 96
  s_load_dwordx2 s[6:7], s[0:1], 40
  s_load_dwordx2 s[56:57], s[0:1], 48
  s_load_dwordx2 s[58:59], s[0:1], 128
  s_load_dwordx2 s[60:61], s[0:1], 0
  s_load_dwordx2 s[62:63], s[0:1], 112
  s_load_dwordx2 s[64:65], s[0:1], 104
  s_load_dwordx2 s[66:67], s[0:1], 64
  v_lshrrev_b32 v1, 6, v0
  s_nop 1
  v_readfirstlane_b32 s3, v1
  v_and_b32 v1, 63, v0
  v_lshrrev_b32 v2, 5, v1
  v_and_b32 v3, 31, v1
  s_nop 2
  s_lshl_b32 s40, s3, 11
  s_and_b32 s45, s2, 7
  s_lshr_b32 s46, s2, 3
  s_lshr_b32 s49, s46, 3
  s_lshl_b32 s50, s45, 2
  s_add_u32 s49, s49, s50
  s_and_b32 s50, s46, 7
  s_lshr_b32 s47, s3, 1
  s_and_b32 s48, s3, 1
  s_waitcnt lgkmcnt(0)
  s_mov_b32 s8, s4
  s_mov_b32 s9, s5
  s_mov_b32 s10, 0x700000
  s_mov_b32 s11, 0x00020000
  s_mov_b32 s12, s6
  s_mov_b32 s13, s7
  s_mov_b32 s14, 0x80000
  s_mov_b32 s15, 0x00020000
  s_mov_b32 s16, s58
  s_mov_b32 s17, s59
  s_mov_b32 s18, 0x10000000
  s_mov_b32 s19, 0x00020000
  s_mov_b32 s20, s56
  s_mov_b32 s21, s57
  s_mov_b32 s22, 0x80000
  s_mov_b32 s23, 0x00020000
  s_mov_b32 s24, s60
  s_mov_b32 s25, s61
  s_mov_b32 s26, 0x200000
  s_mov_b32 s27, 0x00020000
  s_mov_b32 s28, s62
  s_mov_b32 s29, s63
  s_mov_b32 s30, 0x400000
  s_mov_b32 s31, 0x00020000
  s_mov_b32 s68, s64
  s_mov_b32 s69, s65
  s_mov_b32 s70, 0x1000
  s_mov_b32 s71, 0x00020000
  s_mov_b32 s72, s66
  s_mov_b32 s73, s67
  s_mov_b32 s74, 0x400
  s_mov_b32 s75, 0x00020000
  s_lshl_b32 s51, s50, 6
  s_lshl_b32 s52, s48, 5
  s_add_u32 s51, s51, s52
  v_add_u32 v4, s51, v3
  v_lshlrev_b32 v5, 1, v4
  buffer_load_ushort v110, v5, s[72:75], 0 offen
  s_lshl_b32 s52, s49, 6
  s_lshl_b32 s53, s47, 5
  s_add_u32 s52, s52, s53
  v_lshl_add_u32 v6, v2, 2, s52
  v_lshl_add_u32 v111, v6, 10, v5
  v_lshlrev_b32 v112, 1, v6
  s_mov_b32 s54, 0x0
  v_add_u32 v7, 0, v111
  buffer_load_ushort v114, v7, s[24:27], 0 offen
  buffer_load_ushort v130, v7, s[16:19], s54 offen
  buffer_load_ushort v146, v112, s[68:71], 0 offen offset:0
  v_add_u32 v7, 1024, v111
  buffer_load_ushort v115, v7, s[24:27], 0 offen
  buffer_load_ushort v131, v7, s[16:19], s54 offen
  buffer_load_ushort v147, v112, s[68:71], 0 offen offset:2
  v_add_u32 v7, 2048, v111
  buffer_load_ushort v116, v7, s[24:27], 0 offen
  buffer_load_ushort v132, v7, s[16:19], s54 offen
  buffer_load_ushort v148, v112, s[68:71], 0 offen offset:4
  v_add_u32 v7, 3072, v111
  buffer_load_ushort v117, v7, s[24:27], 0 offen
  buffer_load_ushort v133, v7, s[16:19], s54 offen
  buffer_load_ushort v149, v112, s[68:71], 0 offen offset:6
  v_add_u32 v7, 8192, v111
  buffer_load_ushort v118, v7, s[24:27], 0 offen
  buffer_load_ushort v134, v7, s[16:19], s54 offen
  buffer_load_ushort v150, v112, s[68:71], 0 offen offset:16
  v_add_u32 v7, 9216, v111
  buffer_load_ushort v119, v7, s[24:27], 0 offen
  buffer_load_ushort v135, v7, s[16:19], s54 offen
  buffer_load_ushort v151, v112, s[68:71], 0 offen offset:18
  v_add_u32 v7, 10240, v111
  buffer_load_ushort v120, v7, s[24:27], 0 offen
  buffer_load_ushort v136, v7, s[16:19], s54 offen
  buffer_load_ushort v152, v112, s[68:71], 0 offen offset:20
  v_add_u32 v7, 11264, v111
  buffer_load_ushort v121, v7, s[24:27], 0 offen
  buffer_load_ushort v137, v7, s[16:19], s54 offen
  buffer_load_ushort v153, v112, s[68:71], 0 offen offset:22
  v_add_u32 v7, 16384, v111
  buffer_load_ushort v122, v7, s[24:27], 0 offen
  buffer_load_ushort v138, v7, s[16:19], s54 offen
  buffer_load_ushort v154, v112, s[68:71], 0 offen offset:32
  v_add_u32 v7, 17408, v111
  buffer_load_ushort v123, v7, s[24:27], 0 offen
  buffer_load_ushort v139, v7, s[16:19], s54 offen
  buffer_load_ushort v155, v112, s[68:71], 0 offen offset:34
  v_add_u32 v7, 18432, v111
  buffer_load_ushort v124, v7, s[24:27], 0 offen
  buffer_load_ushort v140, v7, s[16:19], s54 offen
  buffer_load_ushort v156, v112, s[68:71], 0 offen offset:36
  v_add_u32 v7, 19456, v111
  buffer_load_ushort v125, v7, s[24:27], 0 offen
  buffer_load_ushort v141, v7, s[16:19], s54 offen
  buffer_load_ushort v157, v112, s[68:71], 0 offen offset:38
  v_add_u32 v7, 24576, v111
  buffer_load_ushort v126, v7, s[24:27], 0 offen
  buffer_load_ushort v142, v7, s[16:19], s54 offen
  buffer_load_ushort v158, v112, s[68:71], 0 offen offset:48
  v_add_u32 v7, 25600, v111
  buffer_load_ushort v127, v7, s[24:27], 0 offen
  buffer_load_ushort v143, v7, s[16:19], s54 offen
  buffer_load_ushort v159, v112, s[68:71], 0 offen offset:50
  v_add_u32 v7, 26624, v111
  buffer_load_ushort v128, v7, s[24:27], 0 offen
  buffer_load_ushort v144, v7, s[16:19], s54 offen
  buffer_load_ushort v160, v112, s[68:71], 0 offen offset:52
  v_add_u32 v7, 27648, v111
  buffer_load_ushort v129, v7, s[24:27], 0 offen
  buffer_load_ushort v145, v7, s[16:19], s54 offen
  buffer_load_ushort v161, v112, s[68:71], 0 offen offset:54
  v_lshrrev_b32 v4, 3, v1
  v_lshl_add_u32 v4, s3, 4, v4
  v_lshrrev_b32 v5, 1, v4
  v_and_b32 v5, 1, v5
  v_lshlrev_b32 v5, 2, v5
  v_and_b32 v6, 7, v1
  v_xor_b32 v5, v5, v6
  v_lshlrev_b32 v5, 4, v5
  s_mov_b32 s44, 4096
  v_mul_lo_u32 v4, v4, s44
  v_add_u32 v72, v4, v5
  v_lshrrev_b32 v4, 3, v1
  v_lshl_add_u32 v4, s3, 4, v4
  v_add_u32 v4, 8, v4
  v_lshrrev_b32 v5, 1, v4
  v_and_b32 v5, 1, v5
  v_lshlrev_b32 v5, 2, v5
  v_and_b32 v6, 7, v1
  v_xor_b32 v5, v5, v6
  v_lshlrev_b32 v5, 4, v5
  s_mov_b32 s44, 4096
  v_mul_lo_u32 v4, v4, s44
  v_add_u32 v73, v4, v5
  v_subrev_u32 v73, 1024, v73
  v_lshrrev_b32 v4, 3, v1
  v_lshl_add_u32 v4, s3, 4, v4
  v_lshrrev_b32 v5, 1, v4
  v_and_b32 v5, 7, v5
  v_and_b32 v6, 7, v1
  v_xor_b32 v5, v5, v6
  v_lshlrev_b32 v5, 4, v5
  s_mov_b32 s44, 3584
  v_mul_lo_u32 v4, v4, s44
  v_add_u32 v74, v4, v5
  v_lshrrev_b32 v4, 3, v1
  v_lshl_add_u32 v4, s3, 4, v4
  v_add_u32 v4, 8, v4
  v_lshrrev_b32 v5, 1, v4
  v_and_b32 v5, 7, v5
  v_and_b32 v6, 7, v1
  v_xor_b32 v5, v5, v6
  v_lshlrev_b32 v5, 4, v5
  s_mov_b32 s44, 3584
  v_mul_lo_u32 v4, v4, s44
  v_add_u32 v75, v4, v5
  v_subrev_u32 v75, 1024, v75
  v_lshrrev_b32 v4, 3, v1
  v_lshl_add_u32 v4, s3, 4, v4
  v_lshrrev_b32 v5, 1, v4
  v_and_b32 v5, 7, v5
  v_and_b32 v6, 7, v1
  v_xor_b32 v5, v5, v6
  v_lshlrev_b32 v5, 4, v5
  s_mov_b32 s44, 2048
  v_mul_lo_u32 v4, v4, s44
  v_add_u32 v76, v4, v5
  v_lshrrev_b32 v4, 3, v1
  v_lshl_add_u32 v4, s3, 4, v4
  v_add_u32 v4, 8, v4
  v_lshrrev_b32 v5, 1, v4
  v_and_b32 v5, 7, v5
  v_and_b32 v6, 7, v1
  v_xor_b32 v5, v5, v6
  v_lshlrev_b32 v5, 4, v5
  s_mov_b32 s44, 2048
  v_mul_lo_u32 v4, v4, s44
  v_add_u32 v77, v4, v5
  v_subrev_u32 v77, 1024, v77
  v_lshrrev_b32 v4, 3, v1
  v_lshl_add_u32 v4, s3, 4, v4
  v_lshrrev_b32 v5, 1, v4
  v_and_b32 v5, 7, v5
  v_and_b32 v6, 7, v1
  v_xor_b32 v5, v5, v6
  v_lshlrev_b32 v5, 4, v5
  s_mov_b32 s44, 1024
  v_mul_lo_u32 v4, v4, s44
  v_add_u32 v78, v4, v5
  v_lshrrev_b32 v4, 3, v1
  v_lshl_add_u32 v4, s3, 4, v4
  v_add_u32 v4, 8, v4
  v_lshrrev_b32 v5, 1, v4
  v_and_b32 v5, 7, v5
  v_and_b32 v6, 7, v1
  v_xor_b32 v5, v5, v6
  v_lshlrev_b32 v5, 4, v5
  s_mov_b32 s44, 1024
  v_mul_lo_u32 v4, v4, s44
  v_add_u32 v79, v4, v5
  v_subrev_u32 v79, 1024, v79
  v_and_b32 v4, 15, v1
  v_lshrrev_b32 v4, 2, v4
  v_lshl_add_u32 v5, v2, 3, v4
  v_lshlrev_b32 v5, 7, v5
  v_lshrrev_b32 v6, 1, v4
  v_and_b32 v6, 1, v6
  v_lshlrev_b32 v6, 2, v6
  v_lshrrev_b32 v7, 4, v1
  v_and_b32 v7, 1, v7
  v_lshlrev_b32 v7, 1, v7
  v_lshl_add_u32 v7, s47, 2, v7
  v_and_b32 v8, 3, v1
  v_lshrrev_b32 v9, 1, v8
  v_add_u32 v7, v7, v9
  v_xor_b32 v7, v7, v6
  v_lshl_add_u32 v5, v7, 4, v5
  v_and_b32 v8, 1, v8
  v_lshl_add_u32 v84, v8, 3, v5
  v_add_u32 v96, 0x10000, v84
  v_lshl_add_u32 v4, s48, 5, v3
  v_lshrrev_b32 v5, 1, v4
  v_and_b32 v5, 7, v5
  v_lshlrev_b32 v4, 7, v4
  v_add_u32 v6, 0, v2
  v_xor_b32 v6, v6, v5
  v_lshl_add_u32 v85, v6, 4, v4
  v_add_u32 v6, 2, v2
  v_xor_b32 v6, v6, v5
  v_lshl_add_u32 v86, v6, 4, v4
  v_add_u32 v6, 4, v2
  v_xor_b32 v6, v6, v5
  v_lshl_add_u32 v87, v6, 4, v4
  v_add_u32 v6, 6, v2
  v_xor_b32 v6, v6, v5
  v_lshl_add_u32 v88, v6, 4, v4
  v_add_u32 v97, 0x10000, v85
  v_add_u32 v98, 0x10000, v86
  v_add_u32 v99, 0x10000, v87
  v_add_u32 v100, 0x10000, v88
  v_lshl_add_u32 v4, s47, 5, v3
  v_lshrrev_b32 v5, 1, v4
  v_and_b32 v5, 7, v5
  v_lshlrev_b32 v4, 7, v4
  v_add_u32 v6, 0, v2
  v_xor_b32 v6, v6, v5
  v_lshl_add_u32 v89, v6, 4, v4
  v_add_u32 v6, 2, v2
  v_xor_b32 v6, v6, v5
  v_lshl_add_u32 v90, v6, 4, v4
  v_add_u32 v6, 4, v2
  v_xor_b32 v6, v6, v5
  v_lshl_add_u32 v91, v6, 4, v4
  v_add_u32 v6, 6, v2
  v_xor_b32 v6, v6, v5
  v_lshl_add_u32 v92, v6, 4, v4
  v_add_u32 v101, 0x10000, v89
  v_add_u32 v102, 0x10000, v90
  v_add_u32 v103, 0x10000, v91
  v_add_u32 v104, 0x10000, v92
  s_lshl_b32 s32, s49, 7
  s_mul_i32 s33, s50, 229376
  s_add_u32 s33, s33, 0x400000
  s_lshl_b32 s34, s49, 17
  s_add_u32 s34, s34, 0x1000000
  s_lshl_b32 s35, s50, 16
  s_mov_b32 s36, s35
  v_mov_b32 v16, 0
  v_mov_b32 v17, 0
  v_mov_b32 v18, 0
  v_mov_b32 v19, 0
  v_mov_b32 v20, 0
  v_mov_b32 v21, 0
  v_mov_b32 v22, 0
  v_mov_b32 v23, 0
  v_mov_b32 v24, 0
  v_mov_b32 v25, 0
  v_mov_b32 v26, 0
  v_mov_b32 v27, 0
  v_mov_b32 v28, 0
  v_mov_b32 v29, 0
  v_mov_b32 v30, 0
  v_mov_b32 v31, 0
  v_mov_b32 v32, 0
  v_mov_b32 v33, 0
  v_mov_b32 v34, 0
  v_mov_b32 v35, 0
  v_mov_b32 v36, 0
  v_mov_b32 v37, 0
  v_mov_b32 v38, 0
  v_mov_b32 v39, 0
  v_mov_b32 v40, 0
  v_mov_b32 v41, 0
  v_mov_b32 v42, 0
  v_mov_b32 v43, 0
  v_mov_b32 v44, 0
  v_mov_b32 v45, 0
  v_mov_b32 v46, 0
  v_mov_b32 v47, 0
  s_add_u32 m0, s40, 0
  s_nop 0
  buffer_load_dwordx4 v72, s[8:11], s32 offen lds
  buffer_load_dwordx4 v73, s[8:11], s32 offen offset:1024 lds
  s_add_u32 s32, s32, 0x40000
  s_add_u32 m0, s40, 8192
  s_nop 0
  buffer_load_dwordx4 v74, s[16:19], s33 offen lds
  buffer_load_dwordx4 v75, s[16:19], s33 offen offset:1024 lds
  s_add_u32 s33, s33, 0x80
  s_add_u32 m0, s40, 16384
  s_nop 0
  buffer_load_dwordx4 v72, s[8:11], s32 offen lds
  buffer_load_dwordx4 v73, s[8:11], s32 offen offset:1024 lds
  s_add_u32 s32, s32, 0x40000
  s_add_u32 m0, s40, 24576
  s_nop 0
  buffer_load_dwordx4 v74, s[16:19], s33 offen lds
  buffer_load_dwordx4 v75, s[16:19], s33 offen offset:1024 lds
  s_add_u32 s33, s33, 0x80
  s_add_u32 m0, s40, 32768
  s_nop 0
  buffer_load_dwordx4 v72, s[8:11], s32 offen lds
  buffer_load_dwordx4 v73, s[8:11], s32 offen offset:1024 lds
  s_add_u32 s32, s32, 0x40000
  s_add_u32 m0, s40, 40960
  s_nop 0
  buffer_load_dwordx4 v74, s[16:19], s33 offen lds
  buffer_load_dwordx4 v75, s[16:19], s33 offen offset:1024 lds
  s_add_u32 s33, s33, 0x80
  s_waitcnt vmcnt(8)
  s_barrier
  s_add_u32 m0, s40, 49152
  s_nop 0
  buffer_load_dwordx4 v72, s[8:11], s32 offen lds
  buffer_load_dwordx4 v73, s[8:11], s32 offen offset:1024 lds
  s_add_u32 s32, s32, 0x40000
  s_add_u32 m0, s40, 57344
  s_nop 0
  buffer_load_dwordx4 v74, s[16:19], s33 offen lds
  buffer_load_dwordx4 v75, s[16:19], s33 offen offset:1024 lds
  s_add_u32 s33, s33, 0x80
  ds_read_b64_tr_b16 v[48:49], v84 offset:0
  ds_read_b64_tr_b16 v[50:51], v84 offset:512
  ds_read_b128 v[52:55], v85 offset:8192
  ds_read_b64_tr_b16 v[60:61], v84 offset:2048
  ds_read_b64_tr_b16 v[62:63], v84 offset:2560
  ds_read_b128 v[64:67], v86 offset:8192
  s_waitcnt lgkmcnt(3)
  v_mfma_f32_32x32x16_bf16 v[16:31], v[48:51], v[52:55], v[16:31]
  ds_read_b64_tr_b16 v[48:49], v84 offset:4096
  ds_read_b64_tr_b16 v[50:51], v84 offset:4608
  ds_read_b128 v[52:55], v87 offset:8192
  s_waitcnt lgkmcnt(3)
  v_mfma_f32_32x32x16_bf16 v[16:31], v[60:63], v[64:67], v[16:31]
  ds_read_b64_tr_b16 v[60:61], v84 offset:6144
  ds_read_b64_tr_b16 v[62:63], v84 offset:6656
  ds_read_b128 v[64:67], v88 offset:8192
  s_waitcnt lgkmcnt(3)
  v_mfma_f32_32x32x16_bf16 v[16:31], v[48:51], v[52:55], v[16:31]
  s_waitcnt lgkmcnt(0)
  v_mfma_f32_32x32x16_bf16 v[16:31], v[60:63], v[64:67], v[16:31]
  s_waitcnt vmcnt(8)
  s_barrier
  s_add_u32 m0, s40, 0
  s_nop 0
  buffer_load_dwordx4 v72, s[8:11], s32 offen lds
  buffer_load_dwordx4 v73, s[8:11], s32 offen offset:1024 lds
  s_add_u32 s32, s32, 0x40000
  s_add_u32 m0, s40, 8192
  s_nop 0
  buffer_load_dwordx4 v74, s[16:19], s33 offen lds
  buffer_load_dwordx4 v75, s[16:19], s33 offen offset:1024 lds
  s_add_u32 s33, s33, 0x80
  ds_read_b64_tr_b16 v[48:49], v84 offset:16384
  ds_read_b64_tr_b16 v[50:51], v84 offset:16896
  ds_read_b128 v[52:55], v85 offset:24576
  ds_read_b64_tr_b16 v[60:61], v84 offset:18432
  ds_read_b64_tr_b16 v[62:63], v84 offset:18944
  ds_read_b128 v[64:67], v86 offset:24576
  s_waitcnt lgkmcnt(3)
  v_mfma_f32_32x32x16_bf16 v[16:31], v[48:51], v[52:55], v[16:31]
  ds_read_b64_tr_b16 v[48:49], v84 offset:20480
  ds_read_b64_tr_b16 v[50:51], v84 offset:20992
  ds_read_b128 v[52:55], v87 offset:24576
  s_waitcnt lgkmcnt(3)
  v_mfma_f32_32x32x16_bf16 v[16:31], v[60:63], v[64:67], v[16:31]
  ds_read_b64_tr_b16 v[60:61], v84 offset:22528
  ds_read_b64_tr_b16 v[62:63], v84 offset:23040
  ds_read_b128 v[64:67], v88 offset:24576
  s_waitcnt lgkmcnt(3)
  v_mfma_f32_32x32x16_bf16 v[16:31], v[48:51], v[52:55], v[16:31]
  s_waitcnt lgkmcnt(0)
  v_mfma_f32_32x32x16_bf16 v[16:31], v[60:63], v[64:67], v[16:31]
  s_waitcnt vmcnt(8)
  s_barrier
  s_add_u32 m0, s40, 16384
  s_nop 0
  buffer_load_dwordx4 v72, s[8:11], s32 offen lds
  buffer_load_dwordx4 v73, s[8:11], s32 offen offset:1024 lds
  s_add_u32 s32, s32, 0x40000
  s_add_u32 m0, s40, 24576
  s_nop 0
  buffer_load_dwordx4 v74, s[16:19], s33 offen lds
  buffer_load_dwordx4 v75, s[16:19], s33 offen offset:1024 lds
  s_add_u32 s33, s33, 0x80
  ds_read_b64_tr_b16 v[48:49], v84 offset:32768
  ds_read_b64_tr_b16 v[50:51], v84 offset:33280
  ds_read_b128 v[52:55], v85 offset:40960
  ds_read_b64_tr_b16 v[60:61], v84 offset:34816
  ds_read_b64_tr_b16 v[62:63], v84 offset:35328
  ds_read_b128 v[64:67], v86 offset:40960
  s_waitcnt lgkmcnt(3)
  v_mfma_f32_32x32x16_bf16 v[16:31], v[48:51], v[52:55], v[16:31]
  ds_read_b64_tr_b16 v[48:49], v84 offset:36864
  ds_read_b64_tr_b16 v[50:51], v84 offset:37376
  ds_read_b128 v[52:55], v87 offset:40960
  s_waitcnt lgkmcnt(3)
  v_mfma_f32_32x32x16_bf16 v[16:31], v[60:63], v[64:67], v[16:31]
  ds_read_b64_tr_b16 v[60:61], v84 offset:38912
  ds_read_b64_tr_b16 v[62:63], v84 offset:39424
  ds_read_b128 v[64:67], v88 offset:40960
  s_waitcnt lgkmcnt(3)
  v_mfma_f32_32x32x16_bf16 v[16:31], v[48:51], v[52:55], v[16:31]
  s_waitcnt lgkmcnt(0)
  v_mfma_f32_32x32x16_bf16 v[16:31], v[60:63], v[64:67], v[16:31]
  s_waitcnt vmcnt(8)
  s_barrier
  s_add_u32 m0, s40, 32768
  s_nop 0
  buffer_load_dwordx4 v72, s[8:11], s32 offen lds
  buffer_load_dwordx4 v73, s[8:11], s32 offen offset:1024 lds
  s_add_u32 s32, s32, 0x40000
  s_add_u32 m0, s40, 40960
  s_nop 0
  buffer_load_dwordx4 v74, s[16:19], s33 offen lds
  buffer_load_dwordx4 v75, s[16:19], s33 offen offset:1024 lds
  s_add_u32 s33, s33, 0x80
  ds_read_b64_tr_b16 v[48:49], v84 offset:49152
  ds_read_b64_tr_b16 v[50:51], v84 offset:49664
  ds_read_b128 v[52:55], v85 offset:57344
  ds_read_b64_tr_b16 v[60:61], v84 offset:51200
  ds_read_b64_tr_b16 v[62:63], v84 offset:51712
  ds_read_b128 v[64:67], v86 offset:57344
  s_waitcnt lgkmcnt(3)
  v_mfma_f32_32x32x16_bf16 v[16:31], v[48:51], v[52:55], v[16:31]
  ds_read_b64_tr_b16 v[48:49], v84 offset:53248
  ds_read_b64_tr_b16 v[50:51], v84 offset:53760
  ds_read_b128 v[52:55], v87 offset:57344
  s_waitcnt lgkmcnt(3)
  v_mfma_f32_32x32x16_bf16 v[16:31], v[60:63], v[64:67], v[16:31]
  ds_read_b64_tr_b16 v[60:61], v84 offset:55296
  ds_read_b64_tr_b16 v[62:63], v84 offset:55808
  ds_read_b128 v[64:67], v88 offset:57344
  s_waitcnt lgkmcnt(3)
  v_mfma_f32_32x32x16_bf16 v[16:31], v[48:51], v[52:55], v[16:31]
  s_waitcnt lgkmcnt(0)
  v_mfma_f32_32x32x16_bf16 v[16:31], v[60:63], v[64:67], v[16:31]
  s_waitcnt vmcnt(8)
  s_barrier
  s_add_u32 m0, s40, 49152
  s_nop 0
  buffer_load_dwordx4 v72, s[8:11], s32 offen lds
  buffer_load_dwordx4 v73, s[8:11], s32 offen offset:1024 lds
  s_add_u32 s32, s32, 0x40000
  s_add_u32 m0, s40, 57344
  s_nop 0
  buffer_load_dwordx4 v74, s[16:19], s33 offen lds
  buffer_load_dwordx4 v75, s[16:19], s33 offen offset:1024 lds
  s_add_u32 s33, s33, 0x80
  ds_read_b64_tr_b16 v[48:49], v84 offset:0
  ds_read_b64_tr_b16 v[50:51], v84 offset:512
  ds_read_b128 v[52:55], v85 offset:8192
  ds_read_b64_tr_b16 v[60:61], v84 offset:2048
  ds_read_b64_tr_b16 v[62:63], v84 offset:2560
  ds_read_b128 v[64:67], v86 offset:8192
  s_waitcnt lgkmcnt(3)
  v_mfma_f32_32x32x16_bf16 v[16:31], v[48:51], v[52:55], v[16:31]
  ds_read_b64_tr_b16 v[48:49], v84 offset:4096
  ds_read_b64_tr_b16 v[50:51], v84 offset:4608
  ds_read_b128 v[52:55], v87 offset:8192
  s_waitcnt lgkmcnt(3)
  v_mfma_f32_32x32x16_bf16 v[16:31], v[60:63], v[64:67], v[16:31]
  ds_read_b64_tr_b16 v[60:61], v84 offset:6144
  ds_read_b64_tr_b16 v[62:63], v84 offset:6656
  ds_read_b128 v[64:67], v88 offset:8192
  s_waitcnt lgkmcnt(3)
  v_mfma_f32_32x32x16_bf16 v[16:31], v[48:51], v[52:55], v[16:31]
  s_waitcnt lgkmcnt(0)
  v_mfma_f32_32x32x16_bf16 v[16:31], v[60:63], v[64:67], v[16:31]
  s_waitcnt vmcnt(8)
  s_barrier
  s_add_u32 m0, s40, 0
  s_nop 0
  buffer_load_dwordx4 v72, s[8:11], s32 offen lds
  buffer_load_dwordx4 v73, s[8:11], s32 offen offset:1024 lds
  s_add_u32 s32, s32, 0x40000
  s_add_u32 m0, s40, 8192
  s_nop 0
  buffer_load_dwordx4 v74, s[16:19], s33 offen lds
  buffer_load_dwordx4 v75, s[16:19], s33 offen offset:1024 lds
  s_add_u32 s33, s33, 0x80
  ds_read_b64_tr_b16 v[48:49], v84 offset:16384
  ds_read_b64_tr_b16 v[50:51], v84 offset:16896
  ds_read_b128 v[52:55], v85 offset:24576
  ds_read_b64_tr_b16 v[60:61], v84 offset:18432
  ds_read_b64_tr_b16 v[62:63], v84 offset:18944
  ds_read_b128 v[64:67], v86 offset:24576
  s_waitcnt lgkmcnt(3)
  v_mfma_f32_32x32x16_bf16 v[16:31], v[48:51], v[52:55], v[16:31]
  ds_read_b64_tr_b16 v[48:49], v84 offset:20480
  ds_read_b64_tr_b16 v[50:51], v84 offset:20992
  ds_read_b128 v[52:55], v87 offset:24576
  s_waitcnt lgkmcnt(3)
  v_mfma_f32_32x32x16_bf16 v[16:31], v[60:63], v[64:67], v[16:31]
  ds_read_b64_tr_b16 v[60:61], v84 offset:22528
  ds_read_b64_tr_b16 v[62:63], v84 offset:23040
  ds_read_b128 v[64:67], v88 offset:24576
  s_waitcnt lgkmcnt(3)
  v_mfma_f32_32x32x16_bf16 v[16:31], v[48:51], v[52:55], v[16:31]
  s_waitcnt lgkmcnt(0)
  v_mfma_f32_32x32x16_bf16 v[16:31], v[60:63], v[64:67], v[16:31]
  s_waitcnt vmcnt(8)
  s_barrier
  s_add_u32 m0, s40, 16384
  s_nop 0
  buffer_load_dwordx4 v72, s[8:11], s32 offen lds
  buffer_load_dwordx4 v73, s[8:11], s32 offen offset:1024 lds
  s_add_u32 s32, s32, 0x40000
  s_add_u32 m0, s40, 24576
  s_nop 0
  buffer_load_dwordx4 v74, s[16:19], s33 offen lds
  buffer_load_dwordx4 v75, s[16:19], s33 offen offset:1024 lds
  s_add_u32 s33, s33, 0x80
  ds_read_b64_tr_b16 v[48:49], v84 offset:32768
  ds_read_b64_tr_b16 v[50:51], v84 offset:33280
  ds_read_b128 v[52:55], v85 offset:40960
  ds_read_b64_tr_b16 v[60:61], v84 offset:34816
  ds_read_b64_tr_b16 v[62:63], v84 offset:35328
  ds_read_b128 v[64:67], v86 offset:40960
  s_waitcnt lgkmcnt(3)
  v_mfma_f32_32x32x16_bf16 v[16:31], v[48:51], v[52:55], v[16:31]
  ds_read_b64_tr_b16 v[48:49], v84 offset:36864
  ds_read_b64_tr_b16 v[50:51], v84 offset:37376
  ds_read_b128 v[52:55], v87 offset:40960
  s_waitcnt lgkmcnt(3)
  v_mfma_f32_32x32x16_bf16 v[16:31], v[60:63], v[64:67], v[16:31]
  ds_read_b64_tr_b16 v[60:61], v84 offset:38912
  ds_read_b64_tr_b16 v[62:63], v84 offset:39424
  ds_read_b128 v[64:67], v88 offset:40960
  s_waitcnt lgkmcnt(3)
  v_mfma_f32_32x32x16_bf16 v[16:31], v[48:51], v[52:55], v[16:31]
  s_waitcnt lgkmcnt(0)
  v_mfma_f32_32x32x16_bf16 v[16:31], v[60:63], v[64:67], v[16:31]
  s_waitcnt vmcnt(8)
  s_barrier
  s_add_u32 m0, s40, 32768
  s_nop 0
  buffer_load_dwordx4 v72, s[8:11], s32 offen lds
  buffer_load_dwordx4 v73, s[8:11], s32 offen offset:1024 lds
  s_add_u32 s32, s32, 0x40000
  s_add_u32 m0, s40, 40960
  s_nop 0
  buffer_load_dwordx4 v74, s[16:19], s33 offen lds
  buffer_load_dwordx4 v75, s[16:19], s33 offen offset:1024 lds
  s_add_u32 s33, s33, 0x80
  ds_read_b64_tr_b16 v[48:49], v84 offset:49152
  ds_read_b64_tr_b16 v[50:51], v84 offset:49664
  ds_read_b128 v[52:55], v85 offset:57344
  ds_read_b64_tr_b16 v[60:61], v84 offset:51200
  ds_read_b64_tr_b16 v[62:63], v84 offset:51712
  ds_read_b128 v[64:67], v86 offset:57344
  s_waitcnt lgkmcnt(3)
  v_mfma_f32_32x32x16_bf16 v[16:31], v[48:51], v[52:55], v[16:31]
  ds_read_b64_tr_b16 v[48:49], v84 offset:53248
  ds_read_b64_tr_b16 v[50:51], v84 offset:53760
  ds_read_b128 v[52:55], v87 offset:57344
  s_waitcnt lgkmcnt(3)
  v_mfma_f32_32x32x16_bf16 v[16:31], v[60:63], v[64:67], v[16:31]
  ds_read_b64_tr_b16 v[60:61], v84 offset:55296
  ds_read_b64_tr_b16 v[62:63], v84 offset:55808
  ds_read_b128 v[64:67], v88 offset:57344
  s_waitcnt lgkmcnt(3)
  v_mfma_f32_32x32x16_bf16 v[16:31], v[48:51], v[52:55], v[16:31]
  s_waitcnt lgkmcnt(0)
  v_mfma_f32_32x32x16_bf16 v[16:31], v[60:63], v[64:67], v[16:31]
  s_waitcnt vmcnt(8)
  s_barrier
  s_add_u32 m0, s40, 49152
  s_nop 0
  buffer_load_dwordx4 v72, s[8:11], s32 offen lds
  buffer_load_dwordx4 v73, s[8:11], s32 offen offset:1024 lds
  s_add_u32 s32, s32, 0x40000
  s_add_u32 m0, s40, 57344
  s_nop 0
  buffer_load_dwordx4 v74, s[16:19], s33 offen lds
  buffer_load_dwordx4 v75, s[16:19], s33 offen offset:1024 lds
  s_add_u32 s33, s33, 0x80
  ds_read_b64_tr_b16 v[48:49], v84 offset:0
  ds_read_b64_tr_b16 v[50:51], v84 offset:512
  ds_read_b128 v[52:55], v85 offset:8192
  ds_read_b64_tr_b16 v[60:61], v84 offset:2048
  ds_read_b64_tr_b16 v[62:63], v84 offset:2560
  ds_read_b128 v[64:67], v86 offset:8192
  s_waitcnt lgkmcnt(3)
  v_mfma_f32_32x32x16_bf16 v[16:31], v[48:51], v[52:55], v[16:31]
  ds_read_b64_tr_b16 v[48:49], v84 offset:4096
  ds_read_b64_tr_b16 v[50:51], v84 offset:4608
  ds_read_b128 v[52:55], v87 offset:8192
  s_waitcnt lgkmcnt(3)
  v_mfma_f32_32x32x16_bf16 v[16:31], v[60:63], v[64:67], v[16:31]
  ds_read_b64_tr_b16 v[60:61], v84 offset:6144
  ds_read_b64_tr_b16 v[62:63], v84 offset:6656
  ds_read_b128 v[64:67], v88 offset:8192
  s_waitcnt lgkmcnt(3)
  v_mfma_f32_32x32x16_bf16 v[16:31], v[48:51], v[52:55], v[16:31]
  s_waitcnt lgkmcnt(0)
  v_mfma_f32_32x32x16_bf16 v[16:31], v[60:63], v[64:67], v[16:31]
  s_waitcnt vmcnt(8)
  s_barrier
  s_add_u32 m0, s40, 0
  s_nop 0
  buffer_load_dwordx4 v72, s[8:11], s32 offen lds
  buffer_load_dwordx4 v73, s[8:11], s32 offen offset:1024 lds
  s_add_u32 s32, s32, 0x40000
  s_add_u32 m0, s40, 8192
  s_nop 0
  buffer_load_dwordx4 v74, s[16:19], s33 offen lds
  buffer_load_dwordx4 v75, s[16:19], s33 offen offset:1024 lds
  s_add_u32 s33, s33, 0x80
  ds_read_b64_tr_b16 v[48:49], v84 offset:16384
  ds_read_b64_tr_b16 v[50:51], v84 offset:16896
  ds_read_b128 v[52:55], v85 offset:24576
  ds_read_b64_tr_b16 v[60:61], v84 offset:18432
  ds_read_b64_tr_b16 v[62:63], v84 offset:18944
  ds_read_b128 v[64:67], v86 offset:24576
  s_waitcnt lgkmcnt(3)
  v_mfma_f32_32x32x16_bf16 v[16:31], v[48:51], v[52:55], v[16:31]
  ds_read_b64_tr_b16 v[48:49], v84 offset:20480
  ds_read_b64_tr_b16 v[50:51], v84 offset:20992
  ds_read_b128 v[52:55], v87 offset:24576
  s_waitcnt lgkmcnt(3)
  v_mfma_f32_32x32x16_bf16 v[16:31], v[60:63], v[64:67], v[16:31]
  ds_read_b64_tr_b16 v[60:61], v84 offset:22528
  ds_read_b64_tr_b16 v[62:63], v84 offset:23040
  ds_read_b128 v[64:67], v88 offset:24576
  s_waitcnt lgkmcnt(3)
  v_mfma_f32_32x32x16_bf16 v[16:31], v[48:51], v[52:55], v[16:31]
  s_waitcnt lgkmcnt(0)
  v_mfma_f32_32x32x16_bf16 v[16:31], v[60:63], v[64:67], v[16:31]
  s_waitcnt vmcnt(8)
  s_barrier
  s_add_u32 m0, s40, 16384
  s_nop 0
  buffer_load_dwordx4 v72, s[8:11], s32 offen lds
  buffer_load_dwordx4 v73, s[8:11], s32 offen offset:1024 lds
  s_add_u32 s32, s32, 0x40000
  s_add_u32 m0, s40, 24576
  s_nop 0
  buffer_load_dwordx4 v74, s[16:19], s33 offen lds
  buffer_load_dwordx4 v75, s[16:19], s33 offen offset:1024 lds
  s_add_u32 s33, s33, 0x80
  ds_read_b64_tr_b16 v[48:49], v84 offset:32768
  ds_read_b64_tr_b16 v[50:51], v84 offset:33280
  ds_read_b128 v[52:55], v85 offset:40960
  ds_read_b64_tr_b16 v[60:61], v84 offset:34816
  ds_read_b64_tr_b16 v[62:63], v84 offset:35328
  ds_read_b128 v[64:67], v86 offset:40960
  s_waitcnt lgkmcnt(3)
  v_mfma_f32_32x32x16_bf16 v[16:31], v[48:51], v[52:55], v[16:31]
  ds_read_b64_tr_b16 v[48:49], v84 offset:36864
  ds_read_b64_tr_b16 v[50:51], v84 offset:37376
  ds_read_b128 v[52:55], v87 offset:40960
  s_waitcnt lgkmcnt(3)
  v_mfma_f32_32x32x16_bf16 v[16:31], v[60:63], v[64:67], v[16:31]
  ds_read_b64_tr_b16 v[60:61], v84 offset:38912
  ds_read_b64_tr_b16 v[62:63], v84 offset:39424
  ds_read_b128 v[64:67], v88 offset:40960
  s_waitcnt lgkmcnt(3)
  v_mfma_f32_32x32x16_bf16 v[16:31], v[48:51], v[52:55], v[16:31]
  s_waitcnt lgkmcnt(0)
  v_mfma_f32_32x32x16_bf16 v[16:31], v[60:63], v[64:67], v[16:31]
  s_waitcnt vmcnt(8)
  s_barrier
  s_add_u32 m0, s40, 32768
  s_nop 0
  buffer_load_dwordx4 v72, s[8:11], s32 offen lds
  buffer_load_dwordx4 v73, s[8:11], s32 offen offset:1024 lds
  s_add_u32 s32, s32, 0x40000
  s_add_u32 m0, s40, 40960
  s_nop 0
  buffer_load_dwordx4 v74, s[16:19], s33 offen lds
  buffer_load_dwordx4 v75, s[16:19], s33 offen offset:1024 lds
  s_add_u32 s33, s33, 0x80
  ds_read_b64_tr_b16 v[48:49], v84 offset:49152
  ds_read_b64_tr_b16 v[50:51], v84 offset:49664
  ds_read_b128 v[52:55], v85 offset:57344
  ds_read_b64_tr_b16 v[60:61], v84 offset:51200
  ds_read_b64_tr_b16 v[62:63], v84 offset:51712
  ds_read_b128 v[64:67], v86 offset:57344
  s_waitcnt lgkmcnt(3)
  v_mfma_f32_32x32x16_bf16 v[16:31], v[48:51], v[52:55], v[16:31]
  ds_read_b64_tr_b16 v[48:49], v84 offset:53248
  ds_read_b64_tr_b16 v[50:51], v84 offset:53760
  ds_read_b128 v[52:55], v87 offset:57344
  s_waitcnt lgkmcnt(3)
  v_mfma_f32_32x32x16_bf16 v[16:31], v[60:63], v[64:67], v[16:31]
  ds_read_b64_tr_b16 v[60:61], v84 offset:55296
  ds_read_b64_tr_b16 v[62:63], v84 offset:55808
  ds_read_b128 v[64:67], v88 offset:57344
  s_waitcnt lgkmcnt(3)
  v_mfma_f32_32x32x16_bf16 v[16:31], v[48:51], v[52:55], v[16:31]
  s_waitcnt lgkmcnt(0)
  v_mfma_f32_32x32x16_bf16 v[16:31], v[60:63], v[64:67], v[16:31]
  s_waitcnt vmcnt(8)
  s_barrier
  s_add_u32 m0, s40, 49152
  s_nop 0
  buffer_load_dwordx4 v72, s[8:11], s32 offen lds
  buffer_load_dwordx4 v73, s[8:11], s32 offen offset:1024 lds
  s_add_u32 s32, s32, 0x40000
  s_add_u32 m0, s40, 57344
  s_nop 0
  buffer_load_dwordx4 v74, s[16:19], s33 offen lds
  buffer_load_dwordx4 v75, s[16:19], s33 offen offset:1024 lds
  s_add_u32 s33, s33, 0x80
  ds_read_b64_tr_b16 v[48:49], v84 offset:0
  ds_read_b64_tr_b16 v[50:51], v84 offset:512
  ds_read_b128 v[52:55], v85 offset:8192
  ds_read_b64_tr_b16 v[60:61], v84 offset:2048
  ds_read_b64_tr_b16 v[62:63], v84 offset:2560
  ds_read_b128 v[64:67], v86 offset:8192
  s_waitcnt lgkmcnt(3)
  v_mfma_f32_32x32x16_bf16 v[16:31], v[48:51], v[52:55], v[16:31]
  ds_read_b64_tr_b16 v[48:49], v84 offset:4096
  ds_read_b64_tr_b16 v[50:51], v84 offset:4608
  ds_read_b128 v[52:55], v87 offset:8192
  s_waitcnt lgkmcnt(3)
  v_mfma_f32_32x32x16_bf16 v[16:31], v[60:63], v[64:67], v[16:31]
  ds_read_b64_tr_b16 v[60:61], v84 offset:6144
  ds_read_b64_tr_b16 v[62:63], v84 offset:6656
  ds_read_b128 v[64:67], v88 offset:8192
  s_waitcnt lgkmcnt(3)
  v_mfma_f32_32x32x16_bf16 v[16:31], v[48:51], v[52:55], v[16:31]
  s_waitcnt lgkmcnt(0)
  v_mfma_f32_32x32x16_bf16 v[16:31], v[60:63], v[64:67], v[16:31]
  s_waitcnt vmcnt(8)
  s_barrier
  s_add_u32 m0, s40, 0
  s_nop 0
  buffer_load_dwordx4 v72, s[8:11], s32 offen lds
  buffer_load_dwordx4 v73, s[8:11], s32 offen offset:1024 lds
  s_add_u32 s32, s32, 0x40000
  s_add_u32 m0, s40, 8192
  s_nop 0
  buffer_load_dwordx4 v74, s[16:19], s33 offen lds
  buffer_load_dwordx4 v75, s[16:19], s33 offen offset:1024 lds
  s_add_u32 s33, s33, 0x80
  ds_read_b64_tr_b16 v[48:49], v84 offset:16384
  ds_read_b64_tr_b16 v[50:51], v84 offset:16896
  ds_read_b128 v[52:55], v85 offset:24576
  ds_read_b64_tr_b16 v[60:61], v84 offset:18432
  ds_read_b64_tr_b16 v[62:63], v84 offset:18944
  ds_read_b128 v[64:67], v86 offset:24576
  s_waitcnt lgkmcnt(3)
  v_mfma_f32_32x32x16_bf16 v[16:31], v[48:51], v[52:55], v[16:31]
  ds_read_b64_tr_b16 v[48:49], v84 offset:20480
  ds_read_b64_tr_b16 v[50:51], v84 offset:20992
  ds_read_b128 v[52:55], v87 offset:24576
  s_waitcnt lgkmcnt(3)
  v_mfma_f32_32x32x16_bf16 v[16:31], v[60:63], v[64:67], v[16:31]
  ds_read_b64_tr_b16 v[60:61], v84 offset:22528
  ds_read_b64_tr_b16 v[62:63], v84 offset:23040
  ds_read_b128 v[64:67], v88 offset:24576
  s_waitcnt lgkmcnt(3)
  v_mfma_f32_32x32x16_bf16 v[16:31], v[48:51], v[52:55], v[16:31]
  s_waitcnt lgkmcnt(0)
  v_mfma_f32_32x32x16_bf16 v[16:31], v[60:63], v[64:67], v[16:31]
  s_waitcnt vmcnt(8)
  s_barrier
  s_add_u32 m0, s40, 16384
  s_nop 0
  buffer_load_dwordx4 v72, s[8:11], s32 offen lds
  buffer_load_dwordx4 v73, s[8:11], s32 offen offset:1024 lds
  s_add_u32 s32, s32, 0x40000
  s_add_u32 m0, s40, 24576
  s_nop 0
  buffer_load_dwordx4 v74, s[16:19], s33 offen lds
  buffer_load_dwordx4 v75, s[16:19], s33 offen offset:1024 lds
  s_add_u32 s33, s33, 0x80
  ds_read_b64_tr_b16 v[48:49], v84 offset:32768
  ds_read_b64_tr_b16 v[50:51], v84 offset:33280
  ds_read_b128 v[52:55], v85 offset:40960
  ds_read_b64_tr_b16 v[60:61], v84 offset:34816
  ds_read_b64_tr_b16 v[62:63], v84 offset:35328
  ds_read_b128 v[64:67], v86 offset:40960
  s_waitcnt lgkmcnt(3)
  v_mfma_f32_32x32x16_bf16 v[16:31], v[48:51], v[52:55], v[16:31]
  ds_read_b64_tr_b16 v[48:49], v84 offset:36864
  ds_read_b64_tr_b16 v[50:51], v84 offset:37376
  ds_read_b128 v[52:55], v87 offset:40960
  s_waitcnt lgkmcnt(3)
  v_mfma_f32_32x32x16_bf16 v[16:31], v[60:63], v[64:67], v[16:31]
  ds_read_b64_tr_b16 v[60:61], v84 offset:38912
  ds_read_b64_tr_b16 v[62:63], v84 offset:39424
  ds_read_b128 v[64:67], v88 offset:40960
  s_waitcnt lgkmcnt(3)
  v_mfma_f32_32x32x16_bf16 v[16:31], v[48:51], v[52:55], v[16:31]
  s_waitcnt lgkmcnt(0)
  v_mfma_f32_32x32x16_bf16 v[16:31], v[60:63], v[64:67], v[16:31]
  s_waitcnt vmcnt(8)
  s_barrier
  s_add_u32 m0, s40, 32768
  s_nop 0
  buffer_load_dwordx4 v72, s[8:11], s32 offen lds
  buffer_load_dwordx4 v73, s[8:11], s32 offen offset:1024 lds
  s_add_u32 s32, s32, 0x40000
  s_add_u32 m0, s40, 40960
  s_nop 0
  buffer_load_dwordx4 v74, s[16:19], s33 offen lds
  buffer_load_dwordx4 v75, s[16:19], s33 offen offset:1024 lds
  s_add_u32 s33, s33, 0x80
  ds_read_b64_tr_b16 v[48:49], v84 offset:49152
  ds_read_b64_tr_b16 v[50:51], v84 offset:49664
  ds_read_b128 v[52:55], v85 offset:57344
  ds_read_b64_tr_b16 v[60:61], v84 offset:51200
  ds_read_b64_tr_b16 v[62:63], v84 offset:51712
  ds_read_b128 v[64:67], v86 offset:57344
  s_waitcnt lgkmcnt(3)
  v_mfma_f32_32x32x16_bf16 v[16:31], v[48:51], v[52:55], v[16:31]
  ds_read_b64_tr_b16 v[48:49], v84 offset:53248
  ds_read_b64_tr_b16 v[50:51], v84 offset:53760
  ds_read_b128 v[52:55], v87 offset:57344
  s_waitcnt lgkmcnt(3)
  v_mfma_f32_32x32x16_bf16 v[16:31], v[60:63], v[64:67], v[16:31]
  ds_read_b64_tr_b16 v[60:61], v84 offset:55296
  ds_read_b64_tr_b16 v[62:63], v84 offset:55808
  ds_read_b128 v[64:67], v88 offset:57344
  s_waitcnt lgkmcnt(3)
  v_mfma_f32_32x32x16_bf16 v[16:31], v[48:51], v[52:55], v[16:31]
  s_waitcnt lgkmcnt(0)
  v_mfma_f32_32x32x16_bf16 v[16:31], v[60:63], v[64:67], v[16:31]
  s_waitcnt vmcnt(8)
  s_barrier
  s_add_u32 m0, s40, 49152
  s_nop 0
  buffer_load_dwordx4 v72, s[8:11], s32 offen lds
  buffer_load_dwordx4 v73, s[8:11], s32 offen offset:1024 lds
  s_add_u32 s32, s32, 0x40000
  s_add_u32 m0, s40, 57344
  s_nop 0
  buffer_load_dwordx4 v74, s[16:19], s33 offen lds
  buffer_load_dwordx4 v75, s[16:19], s33 offen offset:1024 lds
  s_add_u32 s33, s33, 0x80
  ds_read_b64_tr_b16 v[48:49], v84 offset:0
  ds_read_b64_tr_b16 v[50:51], v84 offset:512
  ds_read_b128 v[52:55], v85 offset:8192
  ds_read_b64_tr_b16 v[60:61], v84 offset:2048
  ds_read_b64_tr_b16 v[62:63], v84 offset:2560
  ds_read_b128 v[64:67], v86 offset:8192
  s_waitcnt lgkmcnt(3)
  v_mfma_f32_32x32x16_bf16 v[16:31], v[48:51], v[52:55], v[16:31]
  ds_read_b64_tr_b16 v[48:49], v84 offset:4096
  ds_read_b64_tr_b16 v[50:51], v84 offset:4608
  ds_read_b128 v[52:55], v87 offset:8192
  s_waitcnt lgkmcnt(3)
  v_mfma_f32_32x32x16_bf16 v[16:31], v[60:63], v[64:67], v[16:31]
  ds_read_b64_tr_b16 v[60:61], v84 offset:6144
  ds_read_b64_tr_b16 v[62:63], v84 offset:6656
  ds_read_b128 v[64:67], v88 offset:8192
  s_waitcnt lgkmcnt(3)
  v_mfma_f32_32x32x16_bf16 v[16:31], v[48:51], v[52:55], v[16:31]
  s_waitcnt lgkmcnt(0)
  v_mfma_f32_32x32x16_bf16 v[16:31], v[60:63], v[64:67], v[16:31]
  s_waitcnt vmcnt(8)
  s_barrier
  s_add_u32 m0, s40, 0
  s_nop 0
  buffer_load_dwordx4 v72, s[8:11], s32 offen lds
  buffer_load_dwordx4 v73, s[8:11], s32 offen offset:1024 lds
  s_add_u32 s32, s32, 0x40000
  s_add_u32 m0, s40, 8192
  s_nop 0
  buffer_load_dwordx4 v74, s[16:19], s33 offen lds
  buffer_load_dwordx4 v75, s[16:19], s33 offen offset:1024 lds
  s_add_u32 s33, s33, 0x80
  ds_read_b64_tr_b16 v[48:49], v84 offset:16384
  ds_read_b64_tr_b16 v[50:51], v84 offset:16896
  ds_read_b128 v[52:55], v85 offset:24576
  ds_read_b64_tr_b16 v[60:61], v84 offset:18432
  ds_read_b64_tr_b16 v[62:63], v84 offset:18944
  ds_read_b128 v[64:67], v86 offset:24576
  s_waitcnt lgkmcnt(3)
  v_mfma_f32_32x32x16_bf16 v[16:31], v[48:51], v[52:55], v[16:31]
  ds_read_b64_tr_b16 v[48:49], v84 offset:20480
  ds_read_b64_tr_b16 v[50:51], v84 offset:20992
  ds_read_b128 v[52:55], v87 offset:24576
  s_waitcnt lgkmcnt(3)
  v_mfma_f32_32x32x16_bf16 v[16:31], v[60:63], v[64:67], v[16:31]
  ds_read_b64_tr_b16 v[60:61], v84 offset:22528
  ds_read_b64_tr_b16 v[62:63], v84 offset:23040
  ds_read_b128 v[64:67], v88 offset:24576
  s_waitcnt lgkmcnt(3)
  v_mfma_f32_32x32x16_bf16 v[16:31], v[48:51], v[52:55], v[16:31]
  s_waitcnt lgkmcnt(0)
  v_mfma_f32_32x32x16_bf16 v[16:31], v[60:63], v[64:67], v[16:31]
  s_waitcnt vmcnt(8)
  s_barrier
  s_add_u32 m0, s40, 16384
  s_nop 0
  buffer_load_dwordx4 v72, s[8:11], s32 offen lds
  buffer_load_dwordx4 v73, s[8:11], s32 offen offset:1024 lds
  s_add_u32 s32, s32, 0x40000
  s_add_u32 m0, s40, 24576
  s_nop 0
  buffer_load_dwordx4 v74, s[16:19], s33 offen lds
  buffer_load_dwordx4 v75, s[16:19], s33 offen offset:1024 lds
  s_add_u32 s33, s33, 0x80
  ds_read_b64_tr_b16 v[48:49], v84 offset:32768
  ds_read_b64_tr_b16 v[50:51], v84 offset:33280
  ds_read_b128 v[52:55], v85 offset:40960
  ds_read_b64_tr_b16 v[60:61], v84 offset:34816
  ds_read_b64_tr_b16 v[62:63], v84 offset:35328
  ds_read_b128 v[64:67], v86 offset:40960
  s_waitcnt lgkmcnt(3)
  v_mfma_f32_32x32x16_bf16 v[16:31], v[48:51], v[52:55], v[16:31]
  ds_read_b64_tr_b16 v[48:49], v84 offset:36864
  ds_read_b64_tr_b16 v[50:51], v84 offset:37376
  ds_read_b128 v[52:55], v87 offset:40960
  s_waitcnt lgkmcnt(3)
  v_mfma_f32_32x32x16_bf16 v[16:31], v[60:63], v[64:67], v[16:31]
  ds_read_b64_tr_b16 v[60:61], v84 offset:38912
  ds_read_b64_tr_b16 v[62:63], v84 offset:39424
  ds_read_b128 v[64:67], v88 offset:40960
  s_waitcnt lgkmcnt(3)
  v_mfma_f32_32x32x16_bf16 v[16:31], v[48:51], v[52:55], v[16:31]
  s_waitcnt lgkmcnt(0)
  v_mfma_f32_32x32x16_bf16 v[16:31], v[60:63], v[64:67], v[16:31]
  s_waitcnt vmcnt(8)
  s_barrier
  s_add_u32 m0, s40, 32768
  s_nop 0
  buffer_load_dwordx4 v72, s[8:11], s32 offen lds
  buffer_load_dwordx4 v73, s[8:11], s32 offen offset:1024 lds
  s_add_u32 s32, s32, 0x40000
  s_add_u32 m0, s40, 40960
  s_nop 0
  buffer_load_dwordx4 v74, s[16:19], s33 offen lds
  buffer_load_dwordx4 v75, s[16:19], s33 offen offset:1024 lds
  s_add_u32 s33, s33, 0x80
  ds_read_b64_tr_b16 v[48:49], v84 offset:49152
  ds_read_b64_tr_b16 v[50:51], v84 offset:49664
  ds_read_b128 v[52:55], v85 offset:57344
  ds_read_b64_tr_b16 v[60:61], v84 offset:51200
  ds_read_b64_tr_b16 v[62:63], v84 offset:51712
  ds_read_b128 v[64:67], v86 offset:57344
  s_waitcnt lgkmcnt(3)
  v_mfma_f32_32x32x16_bf16 v[16:31], v[48:51], v[52:55], v[16:31]
  ds_read_b64_tr_b16 v[48:49], v84 offset:53248
  ds_read_b64_tr_b16 v[50:51], v84 offset:53760
  ds_read_b128 v[52:55], v87 offset:57344
  s_waitcnt lgkmcnt(3)
  v_mfma_f32_32x32x16_bf16 v[16:31], v[60:63], v[64:67], v[16:31]
  ds_read_b64_tr_b16 v[60:61], v84 offset:55296
  ds_read_b64_tr_b16 v[62:63], v84 offset:55808
  ds_read_b128 v[64:67], v88 offset:57344
  s_waitcnt lgkmcnt(3)
  v_mfma_f32_32x32x16_bf16 v[16:31], v[48:51], v[52:55], v[16:31]
  s_waitcnt lgkmcnt(0)
  v_mfma_f32_32x32x16_bf16 v[16:31], v[60:63], v[64:67], v[16:31]
  s_waitcnt vmcnt(8)
  s_barrier
  s_add_u32 m0, s40, 49152
  s_nop 0
  buffer_load_dwordx4 v72, s[8:11], s32 offen lds
  buffer_load_dwordx4 v73, s[8:11], s32 offen offset:1024 lds
  s_add_u32 s32, s32, 0x40000
  s_add_u32 m0, s40, 57344
  s_nop 0
  buffer_load_dwordx4 v74, s[16:19], s33 offen lds
  buffer_load_dwordx4 v75, s[16:19], s33 offen offset:1024 lds
  s_add_u32 s33, s33, 0x80
  ds_read_b64_tr_b16 v[48:49], v84 offset:0
  ds_read_b64_tr_b16 v[50:51], v84 offset:512
  ds_read_b128 v[52:55], v85 offset:8192
  ds_read_b64_tr_b16 v[60:61], v84 offset:2048
  ds_read_b64_tr_b16 v[62:63], v84 offset:2560
  ds_read_b128 v[64:67], v86 offset:8192
  s_waitcnt lgkmcnt(3)
  v_mfma_f32_32x32x16_bf16 v[16:31], v[48:51], v[52:55], v[16:31]
  ds_read_b64_tr_b16 v[48:49], v84 offset:4096
  ds_read_b64_tr_b16 v[50:51], v84 offset:4608
  ds_read_b128 v[52:55], v87 offset:8192
  s_waitcnt lgkmcnt(3)
  v_mfma_f32_32x32x16_bf16 v[16:31], v[60:63], v[64:67], v[16:31]
  ds_read_b64_tr_b16 v[60:61], v84 offset:6144
  ds_read_b64_tr_b16 v[62:63], v84 offset:6656
  ds_read_b128 v[64:67], v88 offset:8192
  s_waitcnt lgkmcnt(3)
  v_mfma_f32_32x32x16_bf16 v[16:31], v[48:51], v[52:55], v[16:31]
  s_waitcnt lgkmcnt(0)
  v_mfma_f32_32x32x16_bf16 v[16:31], v[60:63], v[64:67], v[16:31]
  s_waitcnt vmcnt(8)
  s_barrier
  s_add_u32 m0, s40, 0
  s_nop 0
  buffer_load_dwordx4 v72, s[8:11], s32 offen lds
  buffer_load_dwordx4 v73, s[8:11], s32 offen offset:1024 lds
  s_add_u32 s32, s32, 0x40000
  s_add_u32 m0, s40, 8192
  s_nop 0
  buffer_load_dwordx4 v74, s[16:19], s33 offen lds
  buffer_load_dwordx4 v75, s[16:19], s33 offen offset:1024 lds
  s_add_u32 s33, s33, 0x80
  ds_read_b64_tr_b16 v[48:49], v84 offset:16384
  ds_read_b64_tr_b16 v[50:51], v84 offset:16896
  ds_read_b128 v[52:55], v85 offset:24576
  ds_read_b64_tr_b16 v[60:61], v84 offset:18432
  ds_read_b64_tr_b16 v[62:63], v84 offset:18944
  ds_read_b128 v[64:67], v86 offset:24576
  s_waitcnt lgkmcnt(3)
  v_mfma_f32_32x32x16_bf16 v[16:31], v[48:51], v[52:55], v[16:31]
  ds_read_b64_tr_b16 v[48:49], v84 offset:20480
  ds_read_b64_tr_b16 v[50:51], v84 offset:20992
  ds_read_b128 v[52:55], v87 offset:24576
  s_waitcnt lgkmcnt(3)
  v_mfma_f32_32x32x16_bf16 v[16:31], v[60:63], v[64:67], v[16:31]
  ds_read_b64_tr_b16 v[60:61], v84 offset:22528
  ds_read_b64_tr_b16 v[62:63], v84 offset:23040
  ds_read_b128 v[64:67], v88 offset:24576
  s_waitcnt lgkmcnt(3)
  v_mfma_f32_32x32x16_bf16 v[16:31], v[48:51], v[52:55], v[16:31]
  s_waitcnt lgkmcnt(0)
  v_mfma_f32_32x32x16_bf16 v[16:31], v[60:63], v[64:67], v[16:31]
  s_waitcnt vmcnt(8)
  s_barrier
  s_add_u32 m0, s40, 16384
  s_nop 0
  buffer_load_dwordx4 v72, s[8:11], s32 offen lds
  buffer_load_dwordx4 v73, s[8:11], s32 offen offset:1024 lds
  s_add_u32 s32, s32, 0x40000
  s_add_u32 m0, s40, 24576
  s_nop 0
  buffer_load_dwordx4 v74, s[16:19], s33 offen lds
  buffer_load_dwordx4 v75, s[16:19], s33 offen offset:1024 lds
  s_add_u32 s33, s33, 0x80
  ds_read_b64_tr_b16 v[48:49], v84 offset:32768
  ds_read_b64_tr_b16 v[50:51], v84 offset:33280
  ds_read_b128 v[52:55], v85 offset:40960
  ds_read_b64_tr_b16 v[60:61], v84 offset:34816
  ds_read_b64_tr_b16 v[62:63], v84 offset:35328
  ds_read_b128 v[64:67], v86 offset:40960
  s_waitcnt lgkmcnt(3)
  v_mfma_f32_32x32x16_bf16 v[16:31], v[48:51], v[52:55], v[16:31]
  ds_read_b64_tr_b16 v[48:49], v84 offset:36864
  ds_read_b64_tr_b16 v[50:51], v84 offset:37376
  ds_read_b128 v[52:55], v87 offset:40960
  s_waitcnt lgkmcnt(3)
  v_mfma_f32_32x32x16_bf16 v[16:31], v[60:63], v[64:67], v[16:31]
  ds_read_b64_tr_b16 v[60:61], v84 offset:38912
  ds_read_b64_tr_b16 v[62:63], v84 offset:39424
  ds_read_b128 v[64:67], v88 offset:40960
  s_waitcnt lgkmcnt(3)
  v_mfma_f32_32x32x16_bf16 v[16:31], v[48:51], v[52:55], v[16:31]
  s_waitcnt lgkmcnt(0)
  v_mfma_f32_32x32x16_bf16 v[16:31], v[60:63], v[64:67], v[16:31]
  s_waitcnt vmcnt(8)
  s_barrier
  s_add_u32 m0, s40, 32768
  s_nop 0
  buffer_load_dwordx4 v72, s[8:11], s32 offen lds
  buffer_load_dwordx4 v73, s[8:11], s32 offen offset:1024 lds
  s_add_u32 s32, s32, 0x40000
  s_add_u32 m0, s40, 40960
  s_nop 0
  buffer_load_dwordx4 v74, s[16:19], s33 offen lds
  buffer_load_dwordx4 v75, s[16:19], s33 offen offset:1024 lds
  s_add_u32 s33, s33, 0x80
  ds_read_b64_tr_b16 v[48:49], v84 offset:49152
  ds_read_b64_tr_b16 v[50:51], v84 offset:49664
  ds_read_b128 v[52:55], v85 offset:57344
  ds_read_b64_tr_b16 v[60:61], v84 offset:51200
  ds_read_b64_tr_b16 v[62:63], v84 offset:51712
  ds_read_b128 v[64:67], v86 offset:57344
  s_waitcnt lgkmcnt(3)
  v_mfma_f32_32x32x16_bf16 v[16:31], v[48:51], v[52:55], v[16:31]
  ds_read_b64_tr_b16 v[48:49], v84 offset:53248
  ds_read_b64_tr_b16 v[50:51], v84 offset:53760
  ds_read_b128 v[52:55], v87 offset:57344
  s_waitcnt lgkmcnt(3)
  v_mfma_f32_32x32x16_bf16 v[16:31], v[60:63], v[64:67], v[16:31]
  ds_read_b64_tr_b16 v[60:61], v84 offset:55296
  ds_read_b64_tr_b16 v[62:63], v84 offset:55808
  ds_read_b128 v[64:67], v88 offset:57344
  s_waitcnt lgkmcnt(3)
  v_mfma_f32_32x32x16_bf16 v[16:31], v[48:51], v[52:55], v[16:31]
  s_waitcnt lgkmcnt(0)
  v_mfma_f32_32x32x16_bf16 v[16:31], v[60:63], v[64:67], v[16:31]
  s_waitcnt vmcnt(8)
  s_barrier
  s_add_u32 m0, s40, 49152
  s_nop 0
  buffer_load_dwordx4 v72, s[8:11], s32 offen lds
  buffer_load_dwordx4 v73, s[8:11], s32 offen offset:1024 lds
  s_add_u32 s32, s32, 0x40000
  s_add_u32 m0, s40, 57344
  s_nop 0
  buffer_load_dwordx4 v74, s[16:19], s33 offen lds
  buffer_load_dwordx4 v75, s[16:19], s33 offen offset:1024 lds
  s_add_u32 s33, s33, 0x80
  ds_read_b64_tr_b16 v[48:49], v84 offset:0
  ds_read_b64_tr_b16 v[50:51], v84 offset:512
  ds_read_b128 v[52:55], v85 offset:8192
  ds_read_b64_tr_b16 v[60:61], v84 offset:2048
  ds_read_b64_tr_b16 v[62:63], v84 offset:2560
  ds_read_b128 v[64:67], v86 offset:8192
  s_waitcnt lgkmcnt(3)
  v_mfma_f32_32x32x16_bf16 v[16:31], v[48:51], v[52:55], v[16:31]
  ds_read_b64_tr_b16 v[48:49], v84 offset:4096
  ds_read_b64_tr_b16 v[50:51], v84 offset:4608
  ds_read_b128 v[52:55], v87 offset:8192
  s_waitcnt lgkmcnt(3)
  v_mfma_f32_32x32x16_bf16 v[16:31], v[60:63], v[64:67], v[16:31]
  ds_read_b64_tr_b16 v[60:61], v84 offset:6144
  ds_read_b64_tr_b16 v[62:63], v84 offset:6656
  ds_read_b128 v[64:67], v88 offset:8192
  s_waitcnt lgkmcnt(3)
  v_mfma_f32_32x32x16_bf16 v[16:31], v[48:51], v[52:55], v[16:31]
  s_waitcnt lgkmcnt(0)
  v_mfma_f32_32x32x16_bf16 v[16:31], v[60:63], v[64:67], v[16:31]
  s_waitcnt vmcnt(8)
  s_barrier
  s_add_u32 m0, s40, 0
  s_nop 0
  buffer_load_dwordx4 v76, s[16:19], s34 offen lds
  buffer_load_dwordx4 v77, s[16:19], s34 offen offset:1024 lds
  s_add_u32 s34, s34, 0x80
  s_add_u32 m0, s40, 8192
  s_nop 0
  buffer_load_dwordx4 v78, s[12:15], s35 offen lds
  buffer_load_dwordx4 v79, s[12:15], s35 offen offset:1024 lds
  s_add_u32 s35, s35, 0x80
  ds_read_b64_tr_b16 v[48:49], v84 offset:16384
  ds_read_b64_tr_b16 v[50:51], v84 offset:16896
  ds_read_b128 v[52:55], v85 offset:24576
  ds_read_b64_tr_b16 v[60:61], v84 offset:18432
  ds_read_b64_tr_b16 v[62:63], v84 offset:18944
  ds_read_b128 v[64:67], v86 offset:24576
  s_waitcnt lgkmcnt(3)
  v_mfma_f32_32x32x16_bf16 v[16:31], v[48:51], v[52:55], v[16:31]
  ds_read_b64_tr_b16 v[48:49], v84 offset:20480
  ds_read_b64_tr_b16 v[50:51], v84 offset:20992
  ds_read_b128 v[52:55], v87 offset:24576
  s_waitcnt lgkmcnt(3)
  v_mfma_f32_32x32x16_bf16 v[16:31], v[60:63], v[64:67], v[16:31]
  ds_read_b64_tr_b16 v[60:61], v84 offset:22528
  ds_read_b64_tr_b16 v[62:63], v84 offset:23040
  ds_read_b128 v[64:67], v88 offset:24576
  s_waitcnt lgkmcnt(3)
  v_mfma_f32_32x32x16_bf16 v[16:31], v[48:51], v[52:55], v[16:31]
  s_waitcnt lgkmcnt(0)
  v_mfma_f32_32x32x16_bf16 v[16:31], v[60:63], v[64:67], v[16:31]
  s_waitcnt vmcnt(8)
  s_barrier
  s_add_u32 m0, s40, 16384
  s_nop 0
  buffer_load_dwordx4 v76, s[16:19], s34 offen lds
  buffer_load_dwordx4 v77, s[16:19], s34 offen offset:1024 lds
  s_add_u32 s34, s34, 0x80
  s_add_u32 m0, s40, 24576
  s_nop 0
  buffer_load_dwordx4 v78, s[12:15], s35 offen lds
  buffer_load_dwordx4 v79, s[12:15], s35 offen offset:1024 lds
  s_add_u32 s35, s35, 0x80
  ds_read_b64_tr_b16 v[48:49], v84 offset:32768
  ds_read_b64_tr_b16 v[50:51], v84 offset:33280
  ds_read_b128 v[52:55], v85 offset:40960
  ds_read_b64_tr_b16 v[60:61], v84 offset:34816
  ds_read_b64_tr_b16 v[62:63], v84 offset:35328
  ds_read_b128 v[64:67], v86 offset:40960
  s_waitcnt lgkmcnt(3)
  v_mfma_f32_32x32x16_bf16 v[16:31], v[48:51], v[52:55], v[16:31]
  ds_read_b64_tr_b16 v[48:49], v84 offset:36864
  ds_read_b64_tr_b16 v[50:51], v84 offset:37376
  ds_read_b128 v[52:55], v87 offset:40960
  s_waitcnt lgkmcnt(3)
  v_mfma_f32_32x32x16_bf16 v[16:31], v[60:63], v[64:67], v[16:31]
  ds_read_b64_tr_b16 v[60:61], v84 offset:38912
  ds_read_b64_tr_b16 v[62:63], v84 offset:39424
  ds_read_b128 v[64:67], v88 offset:40960
  s_waitcnt lgkmcnt(3)
  v_mfma_f32_32x32x16_bf16 v[16:31], v[48:51], v[52:55], v[16:31]
  s_waitcnt lgkmcnt(0)
  v_mfma_f32_32x32x16_bf16 v[16:31], v[60:63], v[64:67], v[16:31]
  s_waitcnt vmcnt(8)
  s_barrier
  s_add_u32 m0, s40, 32768
  s_nop 0
  buffer_load_dwordx4 v76, s[16:19], s34 offen lds
  buffer_load_dwordx4 v77, s[16:19], s34 offen offset:1024 lds
  s_add_u32 s34, s34, 0x80
  s_add_u32 m0, s40, 40960
  s_nop 0
  buffer_load_dwordx4 v78, s[12:15], s35 offen lds
  buffer_load_dwordx4 v79, s[12:15], s35 offen offset:1024 lds
  s_add_u32 s35, s35, 0x80
  ds_read_b64_tr_b16 v[48:49], v84 offset:49152
  ds_read_b64_tr_b16 v[50:51], v84 offset:49664
  ds_read_b128 v[52:55], v85 offset:57344
  ds_read_b64_tr_b16 v[60:61], v84 offset:51200
  ds_read_b64_tr_b16 v[62:63], v84 offset:51712
  ds_read_b128 v[64:67], v86 offset:57344
  s_waitcnt lgkmcnt(3)
  v_mfma_f32_32x32x16_bf16 v[16:31], v[48:51], v[52:55], v[16:31]
  ds_read_b64_tr_b16 v[48:49], v84 offset:53248
  ds_read_b64_tr_b16 v[50:51], v84 offset:53760
  ds_read_b128 v[52:55], v87 offset:57344
  s_waitcnt lgkmcnt(3)
  v_mfma_f32_32x32x16_bf16 v[16:31], v[60:63], v[64:67], v[16:31]
  ds_read_b64_tr_b16 v[60:61], v84 offset:55296
  ds_read_b64_tr_b16 v[62:63], v84 offset:55808
  ds_read_b128 v[64:67], v88 offset:57344
  s_waitcnt lgkmcnt(3)
  v_mfma_f32_32x32x16_bf16 v[16:31], v[48:51], v[52:55], v[16:31]
  s_waitcnt lgkmcnt(0)
  v_mfma_f32_32x32x16_bf16 v[16:31], v[60:63], v[64:67], v[16:31]
  s_waitcnt vmcnt(8)
  s_barrier
  s_add_u32 m0, s40, 49152
  s_nop 0
  buffer_load_dwordx4 v76, s[16:19], s34 offen lds
  buffer_load_dwordx4 v77, s[16:19], s34 offen offset:1024 lds
  s_add_u32 s34, s34, 0x80
  s_add_u32 m0, s40, 57344
  s_nop 0
  buffer_load_dwordx4 v78, s[12:15], s35 offen lds
  buffer_load_dwordx4 v79, s[12:15], s35 offen offset:1024 lds
  s_add_u32 s35, s35, 0x80
  ds_read_b128 v[48:51], v89 offset:0
  ds_read_b128 v[52:55], v85 offset:8192
  ds_read_b128 v[60:63], v90 offset:0
  ds_read_b128 v[64:67], v86 offset:8192
  s_waitcnt lgkmcnt(2)
  v_mfma_f32_32x32x16_bf16 v[32:47], v[48:51], v[52:55], v[32:47]
  ds_read_b128 v[48:51], v91 offset:0
  ds_read_b128 v[52:55], v87 offset:8192
  s_waitcnt lgkmcnt(2)
  v_mfma_f32_32x32x16_bf16 v[32:47], v[60:63], v[64:67], v[32:47]
  ds_read_b128 v[60:63], v92 offset:0
  ds_read_b128 v[64:67], v88 offset:8192
  s_waitcnt lgkmcnt(2)
  v_mfma_f32_32x32x16_bf16 v[32:47], v[48:51], v[52:55], v[32:47]
  s_waitcnt lgkmcnt(0)
  v_mfma_f32_32x32x16_bf16 v[32:47], v[60:63], v[64:67], v[32:47]
  s_waitcnt vmcnt(8)
  s_barrier
  s_add_u32 m0, s40, 0
  s_nop 0
  buffer_load_dwordx4 v76, s[16:19], s34 offen lds
  buffer_load_dwordx4 v77, s[16:19], s34 offen offset:1024 lds
  s_add_u32 s34, s34, 0x80
  s_add_u32 m0, s40, 8192
  s_nop 0
  buffer_load_dwordx4 v78, s[12:15], s35 offen lds
  buffer_load_dwordx4 v79, s[12:15], s35 offen offset:1024 lds
  s_add_u32 s35, s35, 0x80
  ds_read_b128 v[48:51], v89 offset:16384
  ds_read_b128 v[52:55], v85 offset:24576
  ds_read_b128 v[60:63], v90 offset:16384
  ds_read_b128 v[64:67], v86 offset:24576
  s_waitcnt lgkmcnt(2)
  v_mfma_f32_32x32x16_bf16 v[32:47], v[48:51], v[52:55], v[32:47]
  ds_read_b128 v[48:51], v91 offset:16384
  ds_read_b128 v[52:55], v87 offset:24576
  s_waitcnt lgkmcnt(2)
  v_mfma_f32_32x32x16_bf16 v[32:47], v[60:63], v[64:67], v[32:47]
  ds_read_b128 v[60:63], v92 offset:16384
  ds_read_b128 v[64:67], v88 offset:24576
  s_waitcnt lgkmcnt(2)
  v_mfma_f32_32x32x16_bf16 v[32:47], v[48:51], v[52:55], v[32:47]
  s_waitcnt lgkmcnt(0)
  v_mfma_f32_32x32x16_bf16 v[32:47], v[60:63], v[64:67], v[32:47]
  s_waitcnt vmcnt(8)
  s_barrier
  s_add_u32 m0, s40, 16384
  s_nop 0
  buffer_load_dwordx4 v76, s[16:19], s34 offen lds
  buffer_load_dwordx4 v77, s[16:19], s34 offen offset:1024 lds
  s_add_u32 s34, s34, 0x80
  s_add_u32 m0, s40, 24576
  s_nop 0
  buffer_load_dwordx4 v78, s[12:15], s35 offen lds
  buffer_load_dwordx4 v79, s[12:15], s35 offen offset:1024 lds
  s_add_u32 s35, s35, 0x80
  ds_read_b128 v[48:51], v89 offset:32768
  ds_read_b128 v[52:55], v85 offset:40960
  ds_read_b128 v[60:63], v90 offset:32768
  ds_read_b128 v[64:67], v86 offset:40960
  s_waitcnt lgkmcnt(2)
  v_mfma_f32_32x32x16_bf16 v[32:47], v[48:51], v[52:55], v[32:47]
  ds_read_b128 v[48:51], v91 offset:32768
  ds_read_b128 v[52:55], v87 offset:40960
  s_waitcnt lgkmcnt(2)
  v_mfma_f32_32x32x16_bf16 v[32:47], v[60:63], v[64:67], v[32:47]
  ds_read_b128 v[60:63], v92 offset:32768
  ds_read_b128 v[64:67], v88 offset:40960
  s_waitcnt lgkmcnt(2)
  v_mfma_f32_32x32x16_bf16 v[32:47], v[48:51], v[52:55], v[32:47]
  s_waitcnt lgkmcnt(0)
  v_mfma_f32_32x32x16_bf16 v[32:47], v[60:63], v[64:67], v[32:47]
  s_waitcnt vmcnt(8)
  s_barrier
  s_add_u32 m0, s40, 32768
  s_nop 0
  buffer_load_dwordx4 v76, s[16:19], s34 offen lds
  buffer_load_dwordx4 v77, s[16:19], s34 offen offset:1024 lds
  s_add_u32 s34, s34, 0x80
  s_add_u32 m0, s40, 40960
  s_nop 0
  buffer_load_dwordx4 v78, s[12:15], s35 offen lds
  buffer_load_dwordx4 v79, s[12:15], s35 offen offset:1024 lds
  s_add_u32 s35, s35, 0x80
  ds_read_b128 v[48:51], v89 offset:49152
  ds_read_b128 v[52:55], v85 offset:57344
  ds_read_b128 v[60:63], v90 offset:49152
  ds_read_b128 v[64:67], v86 offset:57344
  s_waitcnt lgkmcnt(2)
  v_mfma_f32_32x32x16_bf16 v[32:47], v[48:51], v[52:55], v[32:47]
  ds_read_b128 v[48:51], v91 offset:49152
  ds_read_b128 v[52:55], v87 offset:57344
  s_waitcnt lgkmcnt(2)
  v_mfma_f32_32x32x16_bf16 v[32:47], v[60:63], v[64:67], v[32:47]
  ds_read_b128 v[60:63], v92 offset:49152
  ds_read_b128 v[64:67], v88 offset:57344
  s_waitcnt lgkmcnt(2)
  v_mfma_f32_32x32x16_bf16 v[32:47], v[48:51], v[52:55], v[32:47]
  s_waitcnt lgkmcnt(0)
  v_mfma_f32_32x32x16_bf16 v[32:47], v[60:63], v[64:67], v[32:47]
  s_waitcnt vmcnt(8)
  s_barrier
  s_add_u32 m0, s40, 49152
  s_nop 0
  buffer_load_dwordx4 v76, s[16:19], s34 offen lds
  buffer_load_dwordx4 v77, s[16:19], s34 offen offset:1024 lds
  s_add_u32 s34, s34, 0x80
  s_add_u32 m0, s40, 57344
  s_nop 0
  buffer_load_dwordx4 v78, s[12:15], s35 offen lds
  buffer_load_dwordx4 v79, s[12:15], s35 offen offset:1024 lds
  s_add_u32 s35, s35, 0x80
  ds_read_b128 v[48:51], v89 offset:0
  ds_read_b128 v[52:55], v85 offset:8192
  ds_read_b128 v[60:63], v90 offset:0
  ds_read_b128 v[64:67], v86 offset:8192
  s_waitcnt lgkmcnt(2)
  v_mfma_f32_32x32x16_bf16 v[32:47], v[48:51], v[52:55], v[32:47]
  ds_read_b128 v[48:51], v91 offset:0
  ds_read_b128 v[52:55], v87 offset:8192
  s_waitcnt lgkmcnt(2)
  v_mfma_f32_32x32x16_bf16 v[32:47], v[60:63], v[64:67], v[32:47]
  ds_read_b128 v[60:63], v92 offset:0
  ds_read_b128 v[64:67], v88 offset:8192
  s_waitcnt lgkmcnt(2)
  v_mfma_f32_32x32x16_bf16 v[32:47], v[48:51], v[52:55], v[32:47]
  s_waitcnt lgkmcnt(0)
  v_mfma_f32_32x32x16_bf16 v[32:47], v[60:63], v[64:67], v[32:47]
  s_waitcnt vmcnt(8)
  s_barrier
  s_add_u32 m0, s40, 0
  s_nop 0
  buffer_load_dwordx4 v76, s[16:19], s34 offen lds
  buffer_load_dwordx4 v77, s[16:19], s34 offen offset:1024 lds
  s_add_u32 s34, s34, 0x80
  s_add_u32 m0, s40, 8192
  s_nop 0
  buffer_load_dwordx4 v78, s[20:23], s36 offen lds
  buffer_load_dwordx4 v79, s[20:23], s36 offen offset:1024 lds
  s_add_u32 s36, s36, 0x80
  ds_read_b128 v[48:51], v89 offset:16384
  ds_read_b128 v[52:55], v85 offset:24576
  ds_read_b128 v[60:63], v90 offset:16384
  ds_read_b128 v[64:67], v86 offset:24576
  s_waitcnt lgkmcnt(2)
  v_mfma_f32_32x32x16_bf16 v[32:47], v[48:51], v[52:55], v[32:47]
  ds_read_b128 v[48:51], v91 offset:16384
  ds_read_b128 v[52:55], v87 offset:24576
  s_waitcnt lgkmcnt(2)
  v_mfma_f32_32x32x16_bf16 v[32:47], v[60:63], v[64:67], v[32:47]
  ds_read_b128 v[60:63], v92 offset:16384
  ds_read_b128 v[64:67], v88 offset:24576
  s_waitcnt lgkmcnt(2)
  v_mfma_f32_32x32x16_bf16 v[32:47], v[48:51], v[52:55], v[32:47]
  s_waitcnt lgkmcnt(0)
  v_mfma_f32_32x32x16_bf16 v[32:47], v[60:63], v[64:67], v[32:47]
  s_waitcnt vmcnt(8)
  s_barrier
  s_add_u32 m0, s40, 16384
  s_nop 0
  buffer_load_dwordx4 v76, s[16:19], s34 offen lds
  buffer_load_dwordx4 v77, s[16:19], s34 offen offset:1024 lds
  s_add_u32 s34, s34, 0x80
  s_add_u32 m0, s40, 24576
  s_nop 0
  buffer_load_dwordx4 v78, s[20:23], s36 offen lds
  buffer_load_dwordx4 v79, s[20:23], s36 offen offset:1024 lds
  s_add_u32 s36, s36, 0x80
  ds_read_b128 v[48:51], v89 offset:32768
  ds_read_b128 v[52:55], v85 offset:40960
  ds_read_b128 v[60:63], v90 offset:32768
  ds_read_b128 v[64:67], v86 offset:40960
  s_waitcnt lgkmcnt(2)
  v_mfma_f32_32x32x16_bf16 v[32:47], v[48:51], v[52:55], v[32:47]
  ds_read_b128 v[48:51], v91 offset:32768
  ds_read_b128 v[52:55], v87 offset:40960
  s_waitcnt lgkmcnt(2)
  v_mfma_f32_32x32x16_bf16 v[32:47], v[60:63], v[64:67], v[32:47]
  ds_read_b128 v[60:63], v92 offset:32768
  ds_read_b128 v[64:67], v88 offset:40960
  s_waitcnt lgkmcnt(2)
  v_mfma_f32_32x32x16_bf16 v[32:47], v[48:51], v[52:55], v[32:47]
  s_waitcnt lgkmcnt(0)
  v_mfma_f32_32x32x16_bf16 v[32:47], v[60:63], v[64:67], v[32:47]
  s_waitcnt vmcnt(8)
  s_barrier
  s_add_u32 m0, s40, 32768
  s_nop 0
  buffer_load_dwordx4 v76, s[16:19], s34 offen lds
  buffer_load_dwordx4 v77, s[16:19], s34 offen offset:1024 lds
  s_add_u32 s34, s34, 0x80
  s_add_u32 m0, s40, 40960
  s_nop 0
  buffer_load_dwordx4 v78, s[20:23], s36 offen lds
  buffer_load_dwordx4 v79, s[20:23], s36 offen offset:1024 lds
  s_add_u32 s36, s36, 0x80
  ds_read_b128 v[48:51], v89 offset:49152
  ds_read_b128 v[52:55], v85 offset:57344
  ds_read_b128 v[60:63], v90 offset:49152
  ds_read_b128 v[64:67], v86 offset:57344
  s_waitcnt lgkmcnt(2)
  v_mfma_f32_32x32x16_bf16 v[32:47], v[48:51], v[52:55], v[32:47]
  ds_read_b128 v[48:51], v91 offset:49152
  ds_read_b128 v[52:55], v87 offset:57344
  s_waitcnt lgkmcnt(2)
  v_mfma_f32_32x32x16_bf16 v[32:47], v[60:63], v[64:67], v[32:47]
  ds_read_b128 v[60:63], v92 offset:49152
  ds_read_b128 v[64:67], v88 offset:57344
  s_waitcnt lgkmcnt(2)
  v_mfma_f32_32x32x16_bf16 v[32:47], v[48:51], v[52:55], v[32:47]
  s_waitcnt lgkmcnt(0)
  v_mfma_f32_32x32x16_bf16 v[32:47], v[60:63], v[64:67], v[32:47]
  s_waitcnt vmcnt(8)
  s_barrier
  s_add_u32 m0, s40, 49152
  s_nop 0
  buffer_load_dwordx4 v76, s[16:19], s34 offen lds
  buffer_load_dwordx4 v77, s[16:19], s34 offen offset:1024 lds
  s_add_u32 s34, s34, 0x80
  s_add_u32 m0, s40, 57344
  s_nop 0
  buffer_load_dwordx4 v78, s[20:23], s36 offen lds
  buffer_load_dwordx4 v79, s[20:23], s36 offen offset:1024 lds
  s_add_u32 s36, s36, 0x80
  ds_read_b128 v[48:51], v89 offset:0
  ds_read_b128 v[52:55], v85 offset:8192
  ds_read_b128 v[60:63], v90 offset:0
  ds_read_b128 v[64:67], v86 offset:8192
  s_waitcnt lgkmcnt(2)
  v_mfma_f32_32x32x16_bf16 v[32:47], v[48:51], v[52:55], v[32:47]
  ds_read_b128 v[48:51], v91 offset:0
  ds_read_b128 v[52:55], v87 offset:8192
  s_waitcnt lgkmcnt(2)
  v_mfma_f32_32x32x16_bf16 v[32:47], v[60:63], v[64:67], v[32:47]
  ds_read_b128 v[60:63], v92 offset:0
  ds_read_b128 v[64:67], v88 offset:8192
  s_waitcnt lgkmcnt(2)
  v_mfma_f32_32x32x16_bf16 v[32:47], v[48:51], v[52:55], v[32:47]
  s_waitcnt lgkmcnt(0)
  v_mfma_f32_32x32x16_bf16 v[32:47], v[60:63], v[64:67], v[32:47]
  s_waitcnt vmcnt(8)
  s_barrier
  s_add_u32 m0, s40, 0
  s_nop 0
  buffer_load_dwordx4 v76, s[16:19], s34 offen lds
  buffer_load_dwordx4 v77, s[16:19], s34 offen offset:1024 lds
  s_add_u32 s34, s34, 0x80
  s_add_u32 m0, s40, 8192
  s_nop 0
  buffer_load_dwordx4 v78, s[20:23], s36 offen lds
  buffer_load_dwordx4 v79, s[20:23], s36 offen offset:1024 lds
  s_add_u32 s36, s36, 0x80
  ds_read_b128 v[48:51], v89 offset:16384
  ds_read_b128 v[52:55], v85 offset:24576
  ds_read_b128 v[60:63], v90 offset:16384
  ds_read_b128 v[64:67], v86 offset:24576
  s_waitcnt lgkmcnt(2)
  v_mfma_f32_32x32x16_bf16 v[32:47], v[48:51], v[52:55], v[32:47]
  ds_read_b128 v[48:51], v91 offset:16384
  ds_read_b128 v[52:55], v87 offset:24576
  s_waitcnt lgkmcnt(2)
  v_mfma_f32_32x32x16_bf16 v[32:47], v[60:63], v[64:67], v[32:47]
  ds_read_b128 v[60:63], v92 offset:16384
  ds_read_b128 v[64:67], v88 offset:24576
  s_waitcnt lgkmcnt(2)
  v_mfma_f32_32x32x16_bf16 v[32:47], v[48:51], v[52:55], v[32:47]
  s_waitcnt lgkmcnt(0)
  v_mfma_f32_32x32x16_bf16 v[32:47], v[60:63], v[64:67], v[32:47]
  s_waitcnt vmcnt(8)
  s_barrier
  s_add_u32 m0, s40, 16384
  s_nop 0
  buffer_load_dwordx4 v76, s[16:19], s34 offen lds
  buffer_load_dwordx4 v77, s[16:19], s34 offen offset:1024 lds
  s_add_u32 s34, s34, 0x80
  s_add_u32 m0, s40, 24576
  s_nop 0
  buffer_load_dwordx4 v78, s[20:23], s36 offen lds
  buffer_load_dwordx4 v79, s[20:23], s36 offen offset:1024 lds
  s_add_u32 s36, s36, 0x80
  ds_read_b128 v[48:51], v89 offset:32768
  ds_read_b128 v[52:55], v85 offset:40960
  ds_read_b128 v[60:63], v90 offset:32768
  ds_read_b128 v[64:67], v86 offset:40960
  s_waitcnt lgkmcnt(2)
  v_mfma_f32_32x32x16_bf16 v[32:47], v[48:51], v[52:55], v[32:47]
  ds_read_b128 v[48:51], v91 offset:32768
  ds_read_b128 v[52:55], v87 offset:40960
  s_waitcnt lgkmcnt(2)
  v_mfma_f32_32x32x16_bf16 v[32:47], v[60:63], v[64:67], v[32:47]
  ds_read_b128 v[60:63], v92 offset:32768
  ds_read_b128 v[64:67], v88 offset:40960
  s_waitcnt lgkmcnt(2)
  v_mfma_f32_32x32x16_bf16 v[32:47], v[48:51], v[52:55], v[32:47]
  s_waitcnt lgkmcnt(0)
  v_mfma_f32_32x32x16_bf16 v[32:47], v[60:63], v[64:67], v[32:47]
  s_waitcnt vmcnt(8)
  s_barrier
  s_add_u32 m0, s40, 32768
  s_nop 0
  buffer_load_dwordx4 v76, s[16:19], s34 offen lds
  buffer_load_dwordx4 v77, s[16:19], s34 offen offset:1024 lds
  s_add_u32 s34, s34, 0x80
  s_add_u32 m0, s40, 40960
  s_nop 0
  buffer_load_dwordx4 v78, s[20:23], s36 offen lds
  buffer_load_dwordx4 v79, s[20:23], s36 offen offset:1024 lds
  s_add_u32 s36, s36, 0x80
  ds_read_b128 v[48:51], v89 offset:49152
  ds_read_b128 v[52:55], v85 offset:57344
  ds_read_b128 v[60:63], v90 offset:49152
  ds_read_b128 v[64:67], v86 offset:57344
  s_waitcnt lgkmcnt(2)
  v_mfma_f32_32x32x16_bf16 v[32:47], v[48:51], v[52:55], v[32:47]
  ds_read_b128 v[48:51], v91 offset:49152
  ds_read_b128 v[52:55], v87 offset:57344
  s_waitcnt lgkmcnt(2)
  v_mfma_f32_32x32x16_bf16 v[32:47], v[60:63], v[64:67], v[32:47]
  ds_read_b128 v[60:63], v92 offset:49152
  ds_read_b128 v[64:67], v88 offset:57344
  s_waitcnt lgkmcnt(2)
  v_mfma_f32_32x32x16_bf16 v[32:47], v[48:51], v[52:55], v[32:47]
  s_waitcnt lgkmcnt(0)
  v_mfma_f32_32x32x16_bf16 v[32:47], v[60:63], v[64:67], v[32:47]
  s_waitcnt vmcnt(8)
  s_barrier
  s_add_u32 m0, s40, 49152
  s_nop 0
  buffer_load_dwordx4 v76, s[16:19], s34 offen lds
  buffer_load_dwordx4 v77, s[16:19], s34 offen offset:1024 lds
  s_add_u32 s34, s34, 0x80
  s_add_u32 m0, s40, 57344
  s_nop 0
  buffer_load_dwordx4 v78, s[20:23], s36 offen lds
  buffer_load_dwordx4 v79, s[20:23], s36 offen offset:1024 lds
  s_add_u32 s36, s36, 0x80
  ds_read_b128 v[48:51], v89 offset:0
  ds_read_b128 v[52:55], v85 offset:8192
  ds_read_b128 v[60:63], v90 offset:0
  ds_read_b128 v[64:67], v86 offset:8192
  s_waitcnt lgkmcnt(2)
  v_mfma_f32_32x32x16_bf16 v[32:47], v[48:51], v[52:55], v[32:47]
  ds_read_b128 v[48:51], v91 offset:0
  ds_read_b128 v[52:55], v87 offset:8192
  s_waitcnt lgkmcnt(2)
  v_mfma_f32_32x32x16_bf16 v[32:47], v[60:63], v[64:67], v[32:47]
  ds_read_b128 v[60:63], v92 offset:0
  ds_read_b128 v[64:67], v88 offset:8192
  s_waitcnt lgkmcnt(2)
  v_mfma_f32_32x32x16_bf16 v[32:47], v[48:51], v[52:55], v[32:47]
  s_waitcnt lgkmcnt(0)
  v_mfma_f32_32x32x16_bf16 v[32:47], v[60:63], v[64:67], v[32:47]
  s_waitcnt vmcnt(8)
  s_barrier
  ds_read_b128 v[48:51], v89 offset:16384
  ds_read_b128 v[52:55], v85 offset:24576
  ds_read_b128 v[60:63], v90 offset:16384
  ds_read_b128 v[64:67], v86 offset:24576
  s_waitcnt lgkmcnt(2)
  v_mfma_f32_32x32x16_bf16 v[32:47], v[48:51], v[52:55], v[32:47]
  ds_read_b128 v[48:51], v91 offset:16384
  ds_read_b128 v[52:55], v87 offset:24576
  s_waitcnt lgkmcnt(2)
  v_mfma_f32_32x32x16_bf16 v[32:47], v[60:63], v[64:67], v[32:47]
  ds_read_b128 v[60:63], v92 offset:16384
  ds_read_b128 v[64:67], v88 offset:24576
  s_waitcnt lgkmcnt(2)
  v_mfma_f32_32x32x16_bf16 v[32:47], v[48:51], v[52:55], v[32:47]
  s_waitcnt lgkmcnt(0)
  v_mfma_f32_32x32x16_bf16 v[32:47], v[60:63], v[64:67], v[32:47]
  s_waitcnt vmcnt(4)
  s_barrier
  ds_read_b128 v[48:51], v89 offset:32768
  ds_read_b128 v[52:55], v85 offset:40960
  ds_read_b128 v[60:63], v90 offset:32768
  ds_read_b128 v[64:67], v86 offset:40960
  s_waitcnt lgkmcnt(2)
  v_mfma_f32_32x32x16_bf16 v[32:47], v[48:51], v[52:55], v[32:47]
  ds_read_b128 v[48:51], v91 offset:32768
  ds_read_b128 v[52:55], v87 offset:40960
  s_waitcnt lgkmcnt(2)
  v_mfma_f32_32x32x16_bf16 v[32:47], v[60:63], v[64:67], v[32:47]
  ds_read_b128 v[60:63], v92 offset:32768
  ds_read_b128 v[64:67], v88 offset:40960
  s_waitcnt lgkmcnt(2)
  v_mfma_f32_32x32x16_bf16 v[32:47], v[48:51], v[52:55], v[32:47]
  s_waitcnt lgkmcnt(0)
  v_mfma_f32_32x32x16_bf16 v[32:47], v[60:63], v[64:67], v[32:47]
  s_waitcnt vmcnt(0)
  s_barrier
  ds_read_b128 v[48:51], v89 offset:49152
  ds_read_b128 v[52:55], v85 offset:57344
  ds_read_b128 v[60:63], v90 offset:49152
  ds_read_b128 v[64:67], v86 offset:57344
  s_waitcnt lgkmcnt(2)
  v_mfma_f32_32x32x16_bf16 v[32:47], v[48:51], v[52:55], v[32:47]
  ds_read_b128 v[48:51], v91 offset:49152
  ds_read_b128 v[52:55], v87 offset:57344
  s_waitcnt lgkmcnt(2)
  v_mfma_f32_32x32x16_bf16 v[32:47], v[60:63], v[64:67], v[32:47]
  ds_read_b128 v[60:63], v92 offset:49152
  ds_read_b128 v[64:67], v88 offset:57344
  s_waitcnt lgkmcnt(2)
  v_mfma_f32_32x32x16_bf16 v[32:47], v[48:51], v[52:55], v[32:47]
  s_waitcnt lgkmcnt(0)
  v_mfma_f32_32x32x16_bf16 v[32:47], v[60:63], v[64:67], v[32:47]
  s_nop 15
  s_nop 7
  v_lshlrev_b32 v110, 16, v110
  v_lshlrev_b32 v113, 1, v111
  s_mov_b32 s55, 0x3fb8aa3b
  v_lshlrev_b32 v114, 16, v114
  v_lshlrev_b32 v130, 16, v130
  v_lshlrev_b32 v146, 16, v146
  v_cvt_pk_bf16_f32 v162, v16, v16
  v_lshlrev_b32 v16, 16, v162
  v_add_f32 v16, v16, v146
  v_cvt_pk_bf16_f32 v162, v16, v16
  v_lshlrev_b32 v16, 16, v162
  v_mul_f32 v162, s55, v16
  v_exp_f32 v162, -v162
  s_nop 0
  v_add_f32 v162, 1.0, v162
  v_rcp_f32 v162, v162
  s_nop 0
  v_mul_f32 v16, v16, v162
  v_cvt_pk_bf16_f32 v162, v16, v16
  v_lshlrev_b32 v16, 16, v162
  v_mul_f32 v130, v130, v110
  v_cvt_pk_bf16_f32 v162, v130, v130
  v_lshlrev_b32 v130, 16, v162
  v_fma_f32 v32, 2.0, v32, v130
  v_fma_f32 v32, v32, v16, v114
  v_add_u32 v163, 0, v113
  buffer_store_dword v32, v163, s[28:31], 0 offen
  v_lshlrev_b32 v115, 16, v115
  v_lshlrev_b32 v131, 16, v131
  v_lshlrev_b32 v147, 16, v147
  v_cvt_pk_bf16_f32 v162, v17, v17
  v_lshlrev_b32 v17, 16, v162
  v_add_f32 v17, v17, v147
  v_cvt_pk_bf16_f32 v162, v17, v17
  v_lshlrev_b32 v17, 16, v162
  v_mul_f32 v162, s55, v17
  v_exp_f32 v162, -v162
  s_nop 0
  v_add_f32 v162, 1.0, v162
  v_rcp_f32 v162, v162
  s_nop 0
  v_mul_f32 v17, v17, v162
  v_cvt_pk_bf16_f32 v162, v17, v17
  v_lshlrev_b32 v17, 16, v162
  v_mul_f32 v131, v131, v110
  v_cvt_pk_bf16_f32 v162, v131, v131
  v_lshlrev_b32 v131, 16, v162
  v_fma_f32 v33, 2.0, v33, v131
  v_fma_f32 v33, v33, v17, v115
  v_add_u32 v163, 2048, v113
  buffer_store_dword v33, v163, s[28:31], 0 offen
  v_lshlrev_b32 v116, 16, v116
  v_lshlrev_b32 v132, 16, v132
  v_lshlrev_b32 v148, 16, v148
  v_cvt_pk_bf16_f32 v162, v18, v18
  v_lshlrev_b32 v18, 16, v162
  v_add_f32 v18, v18, v148
  v_cvt_pk_bf16_f32 v162, v18, v18
  v_lshlrev_b32 v18, 16, v162
  v_mul_f32 v162, s55, v18
  v_exp_f32 v162, -v162
  s_nop 0
  v_add_f32 v162, 1.0, v162
  v_rcp_f32 v162, v162
  s_nop 0
  v_mul_f32 v18, v18, v162
  v_cvt_pk_bf16_f32 v162, v18, v18
  v_lshlrev_b32 v18, 16, v162
  v_mul_f32 v132, v132, v110
  v_cvt_pk_bf16_f32 v162, v132, v132
  v_lshlrev_b32 v132, 16, v162
  v_fma_f32 v34, 2.0, v34, v132
  v_fma_f32 v34, v34, v18, v116
  v_add_u32 v163, 4096, v113
  buffer_store_dword v34, v163, s[28:31], 0 offen
  v_lshlrev_b32 v117, 16, v117
  v_lshlrev_b32 v133, 16, v133
  v_lshlrev_b32 v149, 16, v149
  v_cvt_pk_bf16_f32 v162, v19, v19
  v_lshlrev_b32 v19, 16, v162
  v_add_f32 v19, v19, v149
  v_cvt_pk_bf16_f32 v162, v19, v19
  v_lshlrev_b32 v19, 16, v162
  v_mul_f32 v162, s55, v19
  v_exp_f32 v162, -v162
  s_nop 0
  v_add_f32 v162, 1.0, v162
  v_rcp_f32 v162, v162
  s_nop 0
  v_mul_f32 v19, v19, v162
  v_cvt_pk_bf16_f32 v162, v19, v19
  v_lshlrev_b32 v19, 16, v162
  v_mul_f32 v133, v133, v110
  v_cvt_pk_bf16_f32 v162, v133, v133
  v_lshlrev_b32 v133, 16, v162
  v_fma_f32 v35, 2.0, v35, v133
  v_fma_f32 v35, v35, v19, v117
  v_add_u32 v163, 6144, v113
  buffer_store_dword v35, v163, s[28:31], 0 offen
  v_lshlrev_b32 v118, 16, v118
  v_lshlrev_b32 v134, 16, v134
  v_lshlrev_b32 v150, 16, v150
  v_cvt_pk_bf16_f32 v162, v20, v20
  v_lshlrev_b32 v20, 16, v162
  v_add_f32 v20, v20, v150
  v_cvt_pk_bf16_f32 v162, v20, v20
  v_lshlrev_b32 v20, 16, v162
  v_mul_f32 v162, s55, v20
  v_exp_f32 v162, -v162
  s_nop 0
  v_add_f32 v162, 1.0, v162
  v_rcp_f32 v162, v162
  s_nop 0
  v_mul_f32 v20, v20, v162
  v_cvt_pk_bf16_f32 v162, v20, v20
  v_lshlrev_b32 v20, 16, v162
  v_mul_f32 v134, v134, v110
  v_cvt_pk_bf16_f32 v162, v134, v134
  v_lshlrev_b32 v134, 16, v162
  v_fma_f32 v36, 2.0, v36, v134
  v_fma_f32 v36, v36, v20, v118
  v_add_u32 v163, 16384, v113
  buffer_store_dword v36, v163, s[28:31], 0 offen
  v_lshlrev_b32 v119, 16, v119
  v_lshlrev_b32 v135, 16, v135
  v_lshlrev_b32 v151, 16, v151
  v_cvt_pk_bf16_f32 v162, v21, v21
  v_lshlrev_b32 v21, 16, v162
  v_add_f32 v21, v21, v151
  v_cvt_pk_bf16_f32 v162, v21, v21
  v_lshlrev_b32 v21, 16, v162
  v_mul_f32 v162, s55, v21
  v_exp_f32 v162, -v162
  s_nop 0
  v_add_f32 v162, 1.0, v162
  v_rcp_f32 v162, v162
  s_nop 0
  v_mul_f32 v21, v21, v162
  v_cvt_pk_bf16_f32 v162, v21, v21
  v_lshlrev_b32 v21, 16, v162
  v_mul_f32 v135, v135, v110
  v_cvt_pk_bf16_f32 v162, v135, v135
  v_lshlrev_b32 v135, 16, v162
  v_fma_f32 v37, 2.0, v37, v135
  v_fma_f32 v37, v37, v21, v119
  v_add_u32 v163, 18432, v113
  buffer_store_dword v37, v163, s[28:31], 0 offen
  v_lshlrev_b32 v120, 16, v120
  v_lshlrev_b32 v136, 16, v136
  v_lshlrev_b32 v152, 16, v152
  v_cvt_pk_bf16_f32 v162, v22, v22
  v_lshlrev_b32 v22, 16, v162
  v_add_f32 v22, v22, v152
  v_cvt_pk_bf16_f32 v162, v22, v22
  v_lshlrev_b32 v22, 16, v162
  v_mul_f32 v162, s55, v22
  v_exp_f32 v162, -v162
  s_nop 0
  v_add_f32 v162, 1.0, v162
  v_rcp_f32 v162, v162
  s_nop 0
  v_mul_f32 v22, v22, v162
  v_cvt_pk_bf16_f32 v162, v22, v22
  v_lshlrev_b32 v22, 16, v162
  v_mul_f32 v136, v136, v110
  v_cvt_pk_bf16_f32 v162, v136, v136
  v_lshlrev_b32 v136, 16, v162
  v_fma_f32 v38, 2.0, v38, v136
  v_fma_f32 v38, v38, v22, v120
  v_add_u32 v163, 20480, v113
  buffer_store_dword v38, v163, s[28:31], 0 offen
  v_lshlrev_b32 v121, 16, v121
  v_lshlrev_b32 v137, 16, v137
  v_lshlrev_b32 v153, 16, v153
  v_cvt_pk_bf16_f32 v162, v23, v23
  v_lshlrev_b32 v23, 16, v162
  v_add_f32 v23, v23, v153
  v_cvt_pk_bf16_f32 v162, v23, v23
  v_lshlrev_b32 v23, 16, v162
  v_mul_f32 v162, s55, v23
  v_exp_f32 v162, -v162
  s_nop 0
  v_add_f32 v162, 1.0, v162
  v_rcp_f32 v162, v162
  s_nop 0
  v_mul_f32 v23, v23, v162
  v_cvt_pk_bf16_f32 v162, v23, v23
  v_lshlrev_b32 v23, 16, v162
  v_mul_f32 v137, v137, v110
  v_cvt_pk_bf16_f32 v162, v137, v137
  v_lshlrev_b32 v137, 16, v162
  v_fma_f32 v39, 2.0, v39, v137
  v_fma_f32 v39, v39, v23, v121
  v_add_u32 v163, 22528, v113
  buffer_store_dword v39, v163, s[28:31], 0 offen
  v_lshlrev_b32 v122, 16, v122
  v_lshlrev_b32 v138, 16, v138
  v_lshlrev_b32 v154, 16, v154
  v_cvt_pk_bf16_f32 v162, v24, v24
  v_lshlrev_b32 v24, 16, v162
  v_add_f32 v24, v24, v154
  v_cvt_pk_bf16_f32 v162, v24, v24
  v_lshlrev_b32 v24, 16, v162
  v_mul_f32 v162, s55, v24
  v_exp_f32 v162, -v162
  s_nop 0
  v_add_f32 v162, 1.0, v162
  v_rcp_f32 v162, v162
  s_nop 0
  v_mul_f32 v24, v24, v162
  v_cvt_pk_bf16_f32 v162, v24, v24
  v_lshlrev_b32 v24, 16, v162
  v_mul_f32 v138, v138, v110
  v_cvt_pk_bf16_f32 v162, v138, v138
  v_lshlrev_b32 v138, 16, v162
  v_fma_f32 v40, 2.0, v40, v138
  v_fma_f32 v40, v40, v24, v122
  v_add_u32 v163, 32768, v113
  buffer_store_dword v40, v163, s[28:31], 0 offen
  v_lshlrev_b32 v123, 16, v123
  v_lshlrev_b32 v139, 16, v139
  v_lshlrev_b32 v155, 16, v155
  v_cvt_pk_bf16_f32 v162, v25, v25
  v_lshlrev_b32 v25, 16, v162
  v_add_f32 v25, v25, v155
  v_cvt_pk_bf16_f32 v162, v25, v25
  v_lshlrev_b32 v25, 16, v162
  v_mul_f32 v162, s55, v25
  v_exp_f32 v162, -v162
  s_nop 0
  v_add_f32 v162, 1.0, v162
  v_rcp_f32 v162, v162
  s_nop 0
  v_mul_f32 v25, v25, v162
  v_cvt_pk_bf16_f32 v162, v25, v25
  v_lshlrev_b32 v25, 16, v162
  v_mul_f32 v139, v139, v110
  v_cvt_pk_bf16_f32 v162, v139, v139
  v_lshlrev_b32 v139, 16, v162
  v_fma_f32 v41, 2.0, v41, v139
  v_fma_f32 v41, v41, v25, v123
  v_add_u32 v163, 34816, v113
  buffer_store_dword v41, v163, s[28:31], 0 offen
  v_lshlrev_b32 v124, 16, v124
  v_lshlrev_b32 v140, 16, v140
  v_lshlrev_b32 v156, 16, v156
  v_cvt_pk_bf16_f32 v162, v26, v26
  v_lshlrev_b32 v26, 16, v162
  v_add_f32 v26, v26, v156
  v_cvt_pk_bf16_f32 v162, v26, v26
  v_lshlrev_b32 v26, 16, v162
  v_mul_f32 v162, s55, v26
  v_exp_f32 v162, -v162
  s_nop 0
  v_add_f32 v162, 1.0, v162
  v_rcp_f32 v162, v162
  s_nop 0
  v_mul_f32 v26, v26, v162
  v_cvt_pk_bf16_f32 v162, v26, v26
  v_lshlrev_b32 v26, 16, v162
  v_mul_f32 v140, v140, v110
  v_cvt_pk_bf16_f32 v162, v140, v140
  v_lshlrev_b32 v140, 16, v162
  v_fma_f32 v42, 2.0, v42, v140
  v_fma_f32 v42, v42, v26, v124
  v_add_u32 v163, 36864, v113
  buffer_store_dword v42, v163, s[28:31], 0 offen
  v_lshlrev_b32 v125, 16, v125
  v_lshlrev_b32 v141, 16, v141
  v_lshlrev_b32 v157, 16, v157
  v_cvt_pk_bf16_f32 v162, v27, v27
  v_lshlrev_b32 v27, 16, v162
  v_add_f32 v27, v27, v157
  v_cvt_pk_bf16_f32 v162, v27, v27
  v_lshlrev_b32 v27, 16, v162
  v_mul_f32 v162, s55, v27
  v_exp_f32 v162, -v162
  s_nop 0
  v_add_f32 v162, 1.0, v162
  v_rcp_f32 v162, v162
  s_nop 0
  v_mul_f32 v27, v27, v162
  v_cvt_pk_bf16_f32 v162, v27, v27
  v_lshlrev_b32 v27, 16, v162
  v_mul_f32 v141, v141, v110
  v_cvt_pk_bf16_f32 v162, v141, v141
  v_lshlrev_b32 v141, 16, v162
  v_fma_f32 v43, 2.0, v43, v141
  v_fma_f32 v43, v43, v27, v125
  v_add_u32 v163, 38912, v113
  buffer_store_dword v43, v163, s[28:31], 0 offen
  v_lshlrev_b32 v126, 16, v126
  v_lshlrev_b32 v142, 16, v142
  v_lshlrev_b32 v158, 16, v158
  v_cvt_pk_bf16_f32 v162, v28, v28
  v_lshlrev_b32 v28, 16, v162
  v_add_f32 v28, v28, v158
  v_cvt_pk_bf16_f32 v162, v28, v28
  v_lshlrev_b32 v28, 16, v162
  v_mul_f32 v162, s55, v28
  v_exp_f32 v162, -v162
  s_nop 0
  v_add_f32 v162, 1.0, v162
  v_rcp_f32 v162, v162
  s_nop 0
  v_mul_f32 v28, v28, v162
  v_cvt_pk_bf16_f32 v162, v28, v28
  v_lshlrev_b32 v28, 16, v162
  v_mul_f32 v142, v142, v110
  v_cvt_pk_bf16_f32 v162, v142, v142
  v_lshlrev_b32 v142, 16, v162
  v_fma_f32 v44, 2.0, v44, v142
  v_fma_f32 v44, v44, v28, v126
  v_add_u32 v163, 49152, v113
  buffer_store_dword v44, v163, s[28:31], 0 offen
  v_lshlrev_b32 v127, 16, v127
  v_lshlrev_b32 v143, 16, v143
  v_lshlrev_b32 v159, 16, v159
  v_cvt_pk_bf16_f32 v162, v29, v29
  v_lshlrev_b32 v29, 16, v162
  v_add_f32 v29, v29, v159
  v_cvt_pk_bf16_f32 v162, v29, v29
  v_lshlrev_b32 v29, 16, v162
  v_mul_f32 v162, s55, v29
  v_exp_f32 v162, -v162
  s_nop 0
  v_add_f32 v162, 1.0, v162
  v_rcp_f32 v162, v162
  s_nop 0
  v_mul_f32 v29, v29, v162
  v_cvt_pk_bf16_f32 v162, v29, v29
  v_lshlrev_b32 v29, 16, v162
  v_mul_f32 v143, v143, v110
  v_cvt_pk_bf16_f32 v162, v143, v143
  v_lshlrev_b32 v143, 16, v162
  v_fma_f32 v45, 2.0, v45, v143
  v_fma_f32 v45, v45, v29, v127
  v_add_u32 v163, 51200, v113
  buffer_store_dword v45, v163, s[28:31], 0 offen
  v_lshlrev_b32 v128, 16, v128
  v_lshlrev_b32 v144, 16, v144
  v_lshlrev_b32 v160, 16, v160
  v_cvt_pk_bf16_f32 v162, v30, v30
  v_lshlrev_b32 v30, 16, v162
  v_add_f32 v30, v30, v160
  v_cvt_pk_bf16_f32 v162, v30, v30
  v_lshlrev_b32 v30, 16, v162
  v_mul_f32 v162, s55, v30
  v_exp_f32 v162, -v162
  s_nop 0
  v_add_f32 v162, 1.0, v162
  v_rcp_f32 v162, v162
  s_nop 0
  v_mul_f32 v30, v30, v162
  v_cvt_pk_bf16_f32 v162, v30, v30
  v_lshlrev_b32 v30, 16, v162
  v_mul_f32 v144, v144, v110
  v_cvt_pk_bf16_f32 v162, v144, v144
  v_lshlrev_b32 v144, 16, v162
  v_fma_f32 v46, 2.0, v46, v144
  v_fma_f32 v46, v46, v30, v128
  v_add_u32 v163, 53248, v113
  buffer_store_dword v46, v163, s[28:31], 0 offen
  v_lshlrev_b32 v129, 16, v129
  v_lshlrev_b32 v145, 16, v145
  v_lshlrev_b32 v161, 16, v161
  v_cvt_pk_bf16_f32 v162, v31, v31
  v_lshlrev_b32 v31, 16, v162
  v_add_f32 v31, v31, v161
  v_cvt_pk_bf16_f32 v162, v31, v31
  v_lshlrev_b32 v31, 16, v162
  v_mul_f32 v162, s55, v31
  v_exp_f32 v162, -v162
  s_nop 0
  v_add_f32 v162, 1.0, v162
  v_rcp_f32 v162, v162
  s_nop 0
  v_mul_f32 v31, v31, v162
  v_cvt_pk_bf16_f32 v162, v31, v31
  v_lshlrev_b32 v31, 16, v162
  v_mul_f32 v145, v145, v110
  v_cvt_pk_bf16_f32 v162, v145, v145
  v_lshlrev_b32 v145, 16, v162
  v_fma_f32 v47, 2.0, v47, v145
  v_fma_f32 v47, v47, v31, v129
  v_add_u32 v163, 55296, v113
  buffer_store_dword v47, v163, s[28:31], 0 offen
  s_waitcnt vmcnt(0)
fin_end:
  s_endpgm
.section .rodata,"a"
.p2align 6
.amdhsa_kernel ln_kernel
  .amdhsa_next_free_vgpr 40
  .amdhsa_next_free_sgpr 32
  .amdhsa_accum_offset 40
  .amdhsa_group_segment_fixed_size 0
  .amdhsa_kernarg_size 136
  .amdhsa_user_sgpr_count 2
  .amdhsa_user_sgpr_kernarg_segment_ptr 1
  .amdhsa_system_sgpr_workgroup_id_x 1
.end_amdhsa_kernel
.p2align 6
.amdhsa_kernel c1_kernel
  .amdhsa_next_free_vgpr 136
  .amdhsa_next_free_sgpr 64
  .amdhsa_accum_offset 136
  .amdhsa_group_segment_fixed_size 0
  .amdhsa_kernarg_size 136
  .amdhsa_user_sgpr_count 2
  .amdhsa_user_sgpr_kernarg_segment_ptr 1
  .amdhsa_system_sgpr_workgroup_id_x 1
.end_amdhsa_kernel
.p2align 6
.amdhsa_kernel mid_kernel
  .amdhsa_next_free_vgpr 160
  .amdhsa_next_free_sgpr 64
  .amdhsa_accum_offset 160
  .amdhsa_group_segment_fixed_size 0
  .amdhsa_kernarg_size 136
  .amdhsa_user_sgpr_count 2
  .amdhsa_user_sgpr_kernarg_segment_ptr 1
  .amdhsa_system_sgpr_workgroup_id_x 1
.end_amdhsa_kernel
.p2align 6
.amdhsa_kernel fin_kernel
  .amdhsa_next_free_vgpr 168
  .amdhsa_next_free_sgpr 80
  .amdhsa_accum_offset 168
  .amdhsa_group_segment_fixed_size 0
  .amdhsa_kernarg_size 136
  .amdhsa_user_sgpr_count 2
  .amdhsa_user_sgpr_kernarg_segment_ptr 1
  .amdhsa_system_sgpr_workgroup_id_x 1
.end_amdhsa_kernel
```
